```python
import torch

def _softmax(x, axis=-1):
    return torch.softmax(x, dim=axis)
def _gelu(x):
    return torch.nn.functional.gelu(x, approximate="tanh")
def _silu(x):
    return torch.nn.functional.silu(x)
def _sigmoid(x):
    return torch.sigmoid(x)
def _layernorm(x, axis=-1, eps=1e-5):
    m = x.mean(dim=axis, keepdim=True)
    v = x.var(dim=axis, keepdim=True, unbiased=False)
    return (x - m) / torch.sqrt(v + eps)
def _scatter_add(tgt, idx, src, axis=0):
    return tgt.clone().index_add_(axis, idx, src)
def _segment_sum(src, seg, n):
    out = torch.zeros((n,) + src.shape[1:], dtype=src.dtype)
    return out.index_add_(0, seg, src)
def _pad(x, pw):
    flat = tuple(v for pair in reversed(pw) for v in pair)
    return torch.nn.functional.pad(x, flat)

kernel_name = 'sequential_preLN__ssm_conv_s4__dense_activation_silu__prompt'

def setup_inputs():

    _w = (lambda a: (lambda t: t.to(torch.bfloat16) if t.is_floating_point() else t)(torch.as_tensor(a)))
    def _A_setup():
        B, L, D, N = 1, 2048, 512, 128
        A_re = -(lambda _x: torch.exp(torch.as_tensor(_x)))((lambda *s: torch.randn(*s, dtype=torch.bfloat16) * 6.4)(D, N))
        A_im = torch.pi * (lambda *s: torch.randn(*s, dtype=torch.bfloat16) * 0.05)(D, N)
        B_re = (lambda *s: torch.randn(*s, dtype=torch.bfloat16) * 0.1)(D, N)
        B_im = (lambda *s: torch.randn(*s, dtype=torch.bfloat16) * 0.1)(D, N)
        C_re = (lambda *s: torch.randn(*s, dtype=torch.bfloat16) * 0.1)(D, N)
        C_im = (lambda *s: torch.randn(*s, dtype=torch.bfloat16) * 0.1)(D, N)
        log_dt = (lambda *s: torch.randn(*s, dtype=torch.bfloat16) * 0.05)(D) * 0.5 - 4.0
        Dskip = (lambda *s: torch.randn(*s, dtype=torch.bfloat16) * 0.05)(D)
        return {
            "u": _w((lambda *s: torch.randn(*s, dtype=torch.bfloat16) * 0.05)(B, L, D)),
            "A_re": _w(A_re),
            "A_im": _w(A_im),
            "B_re": _w(B_re),
            "B_im": _w(B_im),
            "C_re": _w(C_re),
            "C_im": _w(C_im),
            "log_dt": _w(log_dt),
            "Dskip": _w(Dskip),
        }
    _A_in = _A_setup()

    def _B_setup():
        B, S, D, F = 1, 2048, 512, 1792
        return {
            "x": _w((lambda *s: torch.randn(*s, dtype=torch.bfloat16) * 0.05)(B, S, D)),
            "w1": _w((lambda *s: torch.randn(*s, dtype=torch.bfloat16) * 0.8)(D, F) * (D ** -0.5)),
            "w2": _w((lambda *s: torch.randn(*s, dtype=torch.bfloat16) * 0.2)(F, D) * (F ** -0.5)),
        }
    _B_in = _B_setup()

    return {
        "A_u": _A_in["u"],
        "A_A_re": _A_in["A_re"],
        "A_A_im": _A_in["A_im"],
        "A_B_re": _A_in["B_re"],
        "A_B_im": _A_in["B_im"],
        "A_C_re": _A_in["C_re"],
        "A_C_im": _A_in["C_im"],
        "A_log_dt": _A_in["log_dt"],
        "A_Dskip": _A_in["Dskip"],
        "B_x": _B_in["x"],
        "B_w1": _B_in["w1"],
        "B_w2": _B_in["w2"],
    }

def reference(A_u, A_A_re, A_A_im, A_B_re, A_B_im, A_C_re, A_C_im, A_log_dt, A_Dskip, B_x, B_w1, B_w2):
    def _A_ref(u, A_re, A_im, B_re, B_im, C_re, C_im, log_dt, Dskip):
        Bsz, L, D = u.shape
        dt = torch.exp(log_dt)[:, None]
        A = A_re + 1j * A_im
        Bc = B_re + 1j * B_im
        Cc = C_re + 1j * C_im
        logdA = dt * A
        dB = dt * Bc
        l = (lambda x, dt: x.to(dt))(torch.arange(L), A_re.dtype)
        P = torch.exp(logdA[:, :, None] * l[None, None, :])
        K = torch.einsum("dn,dnl,dn->dl", Cc, P, dB).real
        L2 = 2 * L
        Kp = _pad(K, ((0, 0), (0, L)))
        up = (lambda x, *d: x.permute(*d))(u, 0, 2, 1)
        up = _pad(up, ((0, 0), (0, 0), (0, L)))
        Kf = (lambda x, axes=(-2,-1): torch.fft.rfft2(x.float(), dim=axes))(Kp[:, None, :], axes=(-2, -1))
        Uf = (lambda x, axes=(-2,-1): torch.fft.rfft2(x.float(), dim=axes))(up[:, :, None, :], axes=(-2, -1))
        Yf = Uf * Kf[None, :, :, :]
        y = (lambda x, s, axes=(-2,-1): torch.fft.irfft2(x, s=s, dim=axes).to(torch.bfloat16))(Yf, (1, L2), axes=(-2, -1))[:, :, 0, :L]
        y = (lambda x, *d: x.permute(*d))(y, 0, 2, 1) + u * Dskip[None, None, :]
        return y

    def _B_ref(x, w1, w2):
        h = torch.einsum("bsd,df->bsf", x, w1)
        h = _silu(h)
        out = torch.einsum("bsf,fd->bsd", h, w2)
        return out

    x = A_u
    h = x + _A_ref(_layernorm(x, axis=-1), A_A_re, A_A_im, A_B_re, A_B_im, A_C_re, A_C_im, A_log_dt, A_Dskip)
    h2 = h + _B_ref(_layernorm(h, axis=-1), B_w1, B_w2)
    return h2
```

```asm
; @launch kernel=lnt_kernel grid=(576,1,1) block=(256,1,1) lds=36864
; @launch kernel=conv_kernel grid=(256,1,1) block=(512,1,1) lds=134016
; @launch kernel=ln2_kernel grid=(128,1,1) block=(256,1,1) lds=16640
; @launch kernel=ffn1_kernel grid=(256,1,1) block=(256,1,1) lds=69120
; @launch kernel=ffn2_kernel grid=(256,1,1) block=(512,1,1) lds=139264
.amdgcn_target "amdgcn-amd-amdhsa--gfx950"
.text
.p2align 8
lnt_kernel:
    s_cmp_ge_u32 s2, 576
    s_cbranch_scc1 LA_done
    s_load_dwordx2 s[4:5], s[0:1], 0
    s_load_dwordx2 s[6:7], s[0:1], 112
    s_load_dwordx2 s[8:9], s[0:1], 80
    s_load_dwordx2 s[10:11], s[0:1], 88
    s_waitcnt lgkmcnt(0)

    s_mov_b32 s16, s6
    s_mov_b32 s17, s7
    s_mov_b32 s18, 33554432
    s_mov_b32 s19, 0x00020000
    s_cmp_ge_u32 s2, 128
    s_cbranch_scc1 LA_tr
    s_mov_b32 s12, s4
    s_mov_b32 s13, s5
    s_mov_b32 s14, 2097152
    s_mov_b32 s15, 0x00020000
    v_and_b32 v1, 63, v0
    v_lshrrev_b32 v2, 6, v0
    s_lshl_b32 s20, s2, 14
    v_lshlrev_b32 v3, 12, v2
    v_lshl_add_u32 v3, v1, 4, v3
    v_add_u32 v3, s20, v3
    buffer_load_dwordx4 v[8:11], v3, s[12:15], 0 offen
    buffer_load_dwordx4 v[12:15], v3, s[12:15], 0 offen offset:1024
    buffer_load_dwordx4 v[16:19], v3, s[12:15], 0 offen offset:2048
    buffer_load_dwordx4 v[20:23], v3, s[12:15], 0 offen offset:3072

    v_xor_b32 v24, 1, v1
    v_lshlrev_b32 v24, 2, v24
    v_xor_b32 v25, 2, v1
    v_lshlrev_b32 v25, 2, v25
    v_xor_b32 v26, 4, v1
    v_lshlrev_b32 v26, 2, v26
    v_xor_b32 v27, 8, v1
    v_lshlrev_b32 v27, 2, v27
    v_xor_b32 v28, 16, v1
    v_lshlrev_b32 v28, 2, v28
    v_xor_b32 v29, 32, v1
    v_lshlrev_b32 v29, 2, v29
    s_waitcnt vmcnt(0)
    v_lshlrev_b32 v32, 16, v8
    v_and_b32 v33, 0xffff0000, v8
    v_lshlrev_b32 v34, 16, v9
    v_and_b32 v35, 0xffff0000, v9
    v_lshlrev_b32 v36, 16, v10
    v_and_b32 v37, 0xffff0000, v10
    v_lshlrev_b32 v38, 16, v11
    v_and_b32 v39, 0xffff0000, v11
    v_lshlrev_b32 v40, 16, v12
    v_and_b32 v41, 0xffff0000, v12
    v_lshlrev_b32 v42, 16, v13
    v_and_b32 v43, 0xffff0000, v13
    v_lshlrev_b32 v44, 16, v14
    v_and_b32 v45, 0xffff0000, v14
    v_lshlrev_b32 v46, 16, v15
    v_and_b32 v47, 0xffff0000, v15
    v_lshlrev_b32 v48, 16, v16
    v_and_b32 v49, 0xffff0000, v16
    v_lshlrev_b32 v50, 16, v17
    v_and_b32 v51, 0xffff0000, v17
    v_lshlrev_b32 v52, 16, v18
    v_and_b32 v53, 0xffff0000, v18
    v_lshlrev_b32 v54, 16, v19
    v_and_b32 v55, 0xffff0000, v19
    v_lshlrev_b32 v56, 16, v20
    v_and_b32 v57, 0xffff0000, v20
    v_lshlrev_b32 v58, 16, v21
    v_and_b32 v59, 0xffff0000, v21
    v_lshlrev_b32 v60, 16, v22
    v_and_b32 v61, 0xffff0000, v22
    v_lshlrev_b32 v62, 16, v23
    v_and_b32 v63, 0xffff0000, v23
    v_add_f32 v64, v32, v33
    v_add_f32 v64, v64, v34
    v_add_f32 v64, v64, v35
    v_add_f32 v64, v64, v36
    v_add_f32 v64, v64, v37
    v_add_f32 v64, v64, v38
    v_add_f32 v64, v64, v39
    v_add_f32 v65, v40, v41
    v_add_f32 v65, v65, v42
    v_add_f32 v65, v65, v43
    v_add_f32 v65, v65, v44
    v_add_f32 v65, v65, v45
    v_add_f32 v65, v65, v46
    v_add_f32 v65, v65, v47
    v_add_f32 v66, v48, v49
    v_add_f32 v66, v66, v50
    v_add_f32 v66, v66, v51
    v_add_f32 v66, v66, v52
    v_add_f32 v66, v66, v53
    v_add_f32 v66, v66, v54
    v_add_f32 v66, v66, v55
    v_add_f32 v67, v56, v57
    v_add_f32 v67, v67, v58
    v_add_f32 v67, v67, v59
    v_add_f32 v67, v67, v60
    v_add_f32 v67, v67, v61
    v_add_f32 v67, v67, v62
    v_add_f32 v67, v67, v63
    ds_bpermute_b32 v72, v24, v64
    ds_bpermute_b32 v73, v24, v65
    ds_bpermute_b32 v74, v24, v66
    ds_bpermute_b32 v75, v24, v67
    s_waitcnt lgkmcnt(0)
    v_add_f32 v64, v64, v72
    v_add_f32 v65, v65, v73
    v_add_f32 v66, v66, v74
    v_add_f32 v67, v67, v75
    ds_bpermute_b32 v72, v25, v64
    ds_bpermute_b32 v73, v25, v65
    ds_bpermute_b32 v74, v25, v66
    ds_bpermute_b32 v75, v25, v67
    s_waitcnt lgkmcnt(0)
    v_add_f32 v64, v64, v72
    v_add_f32 v65, v65, v73
    v_add_f32 v66, v66, v74
    v_add_f32 v67, v67, v75
    ds_bpermute_b32 v72, v26, v64
    ds_bpermute_b32 v73, v26, v65
    ds_bpermute_b32 v74, v26, v66
    ds_bpermute_b32 v75, v26, v67
    s_waitcnt lgkmcnt(0)
    v_add_f32 v64, v64, v72
    v_add_f32 v65, v65, v73
    v_add_f32 v66, v66, v74
    v_add_f32 v67, v67, v75
    ds_bpermute_b32 v72, v27, v64
    ds_bpermute_b32 v73, v27, v65
    ds_bpermute_b32 v74, v27, v66
    ds_bpermute_b32 v75, v27, v67
    s_waitcnt lgkmcnt(0)
    v_add_f32 v64, v64, v72
    v_add_f32 v65, v65, v73
    v_add_f32 v66, v66, v74
    v_add_f32 v67, v67, v75
    ds_bpermute_b32 v72, v28, v64
    ds_bpermute_b32 v73, v28, v65
    ds_bpermute_b32 v74, v28, v66
    ds_bpermute_b32 v75, v28, v67
    s_waitcnt lgkmcnt(0)
    v_add_f32 v64, v64, v72
    v_add_f32 v65, v65, v73
    v_add_f32 v66, v66, v74
    v_add_f32 v67, v67, v75
    ds_bpermute_b32 v72, v29, v64
    ds_bpermute_b32 v73, v29, v65
    ds_bpermute_b32 v74, v29, v66
    ds_bpermute_b32 v75, v29, v67
    s_waitcnt lgkmcnt(0)
    v_add_f32 v64, v64, v72
    v_add_f32 v65, v65, v73
    v_add_f32 v66, v66, v74
    v_add_f32 v67, v67, v75
    v_mul_f32 v64, 0x3b000000, v64
    v_mov_b32 v68, 0
    v_sub_f32 v76, v32, v64
    v_fmac_f32 v68, v76, v76
    v_sub_f32 v76, v33, v64
    v_fmac_f32 v68, v76, v76
    v_sub_f32 v76, v34, v64
    v_fmac_f32 v68, v76, v76
    v_sub_f32 v76, v35, v64
    v_fmac_f32 v68, v76, v76
    v_sub_f32 v76, v36, v64
    v_fmac_f32 v68, v76, v76
    v_sub_f32 v76, v37, v64
    v_fmac_f32 v68, v76, v76
    v_sub_f32 v76, v38, v64
    v_fmac_f32 v68, v76, v76
    v_sub_f32 v76, v39, v64
    v_fmac_f32 v68, v76, v76
    v_mul_f32 v65, 0x3b000000, v65
    v_mov_b32 v69, 0
    v_sub_f32 v76, v40, v65
    v_fmac_f32 v69, v76, v76
    v_sub_f32 v76, v41, v65
    v_fmac_f32 v69, v76, v76
    v_sub_f32 v76, v42, v65
    v_fmac_f32 v69, v76, v76
    v_sub_f32 v76, v43, v65
    v_fmac_f32 v69, v76, v76
    v_sub_f32 v76, v44, v65
    v_fmac_f32 v69, v76, v76
    v_sub_f32 v76, v45, v65
    v_fmac_f32 v69, v76, v76
    v_sub_f32 v76, v46, v65
    v_fmac_f32 v69, v76, v76
    v_sub_f32 v76, v47, v65
    v_fmac_f32 v69, v76, v76
    v_mul_f32 v66, 0x3b000000, v66
    v_mov_b32 v70, 0
    v_sub_f32 v76, v48, v66
    v_fmac_f32 v70, v76, v76
    v_sub_f32 v76, v49, v66
    v_fmac_f32 v70, v76, v76
    v_sub_f32 v76, v50, v66
    v_fmac_f32 v70, v76, v76
    v_sub_f32 v76, v51, v66
    v_fmac_f32 v70, v76, v76
    v_sub_f32 v76, v52, v66
    v_fmac_f32 v70, v76, v76
    v_sub_f32 v76, v53, v66
    v_fmac_f32 v70, v76, v76
    v_sub_f32 v76, v54, v66
    v_fmac_f32 v70, v76, v76
    v_sub_f32 v76, v55, v66
    v_fmac_f32 v70, v76, v76
    v_mul_f32 v67, 0x3b000000, v67
    v_mov_b32 v71, 0
    v_sub_f32 v76, v56, v67
    v_fmac_f32 v71, v76, v76
    v_sub_f32 v76, v57, v67
    v_fmac_f32 v71, v76, v76
    v_sub_f32 v76, v58, v67
    v_fmac_f32 v71, v76, v76
    v_sub_f32 v76, v59, v67
    v_fmac_f32 v71, v76, v76
    v_sub_f32 v76, v60, v67
    v_fmac_f32 v71, v76, v76
    v_sub_f32 v76, v61, v67
    v_fmac_f32 v71, v76, v76
    v_sub_f32 v76, v62, v67
    v_fmac_f32 v71, v76, v76
    v_sub_f32 v76, v63, v67
    v_fmac_f32 v71, v76, v76
    ds_bpermute_b32 v72, v24, v68
    ds_bpermute_b32 v73, v24, v69
    ds_bpermute_b32 v74, v24, v70
    ds_bpermute_b32 v75, v24, v71
    s_waitcnt lgkmcnt(0)
    v_add_f32 v68, v68, v72
    v_add_f32 v69, v69, v73
    v_add_f32 v70, v70, v74
    v_add_f32 v71, v71, v75
    ds_bpermute_b32 v72, v25, v68
    ds_bpermute_b32 v73, v25, v69
    ds_bpermute_b32 v74, v25, v70
    ds_bpermute_b32 v75, v25, v71
    s_waitcnt lgkmcnt(0)
    v_add_f32 v68, v68, v72
    v_add_f32 v69, v69, v73
    v_add_f32 v70, v70, v74
    v_add_f32 v71, v71, v75
    ds_bpermute_b32 v72, v26, v68
    ds_bpermute_b32 v73, v26, v69
    ds_bpermute_b32 v74, v26, v70
    ds_bpermute_b32 v75, v26, v71
    s_waitcnt lgkmcnt(0)
    v_add_f32 v68, v68, v72
    v_add_f32 v69, v69, v73
    v_add_f32 v70, v70, v74
    v_add_f32 v71, v71, v75
    ds_bpermute_b32 v72, v27, v68
    ds_bpermute_b32 v73, v27, v69
    ds_bpermute_b32 v74, v27, v70
    ds_bpermute_b32 v75, v27, v71
    s_waitcnt lgkmcnt(0)
    v_add_f32 v68, v68, v72
    v_add_f32 v69, v69, v73
    v_add_f32 v70, v70, v74
    v_add_f32 v71, v71, v75
    ds_bpermute_b32 v72, v28, v68
    ds_bpermute_b32 v73, v28, v69
    ds_bpermute_b32 v74, v28, v70
    ds_bpermute_b32 v75, v28, v71
    s_waitcnt lgkmcnt(0)
    v_add_f32 v68, v68, v72
    v_add_f32 v69, v69, v73
    v_add_f32 v70, v70, v74
    v_add_f32 v71, v71, v75
    ds_bpermute_b32 v72, v29, v68
    ds_bpermute_b32 v73, v29, v69
    ds_bpermute_b32 v74, v29, v70
    ds_bpermute_b32 v75, v29, v71
    s_waitcnt lgkmcnt(0)
    v_add_f32 v68, v68, v72
    v_add_f32 v69, v69, v73
    v_add_f32 v70, v70, v74
    v_add_f32 v71, v71, v75
    v_lshlrev_b32 v80, 8, v1
    v_lshl_add_u32 v80, v1, 4, v80
    v_lshl_add_u32 v80, v2, 3, v80

    v_mul_f32 v68, 0x3b000000, v68
    v_cvt_pk_bf16_f32 v64, v64, v64
    v_lshlrev_b32 v64, 16, v64
    v_cvt_pk_bf16_f32 v68, v68, v68
    v_lshlrev_b32 v68, 16, v68
    v_add_f32 v68, 0x3727c5ac, v68
    v_cvt_pk_bf16_f32 v68, v68, v68
    v_lshlrev_b32 v68, 16, v68
    v_sqrt_f32 v68, v68
    s_nop 0
    v_cvt_pk_bf16_f32 v68, v68, v68
    v_lshlrev_b32 v68, 16, v68
    v_rcp_f32 v68, v68
    s_nop 0
    v_sub_f32 v32, v32, v64
    v_sub_f32 v33, v33, v64
    v_cvt_pk_bf16_f32 v76, v32, v33
    v_lshlrev_b32 v32, 16, v76
    v_and_b32 v33, 0xffff0000, v76
    v_mul_f32 v32, v32, v68
    v_mul_f32 v33, v33, v68
    v_cvt_pk_bf16_f32 v76, v32, v33
    ds_write_b16 v80, v76 offset:0
    ds_write_b16_d16_hi v80, v76 offset:32
    ds_write_b16 v80, v8 offset:17408
    ds_write_b16_d16_hi v80, v8 offset:17440
    v_sub_f32 v34, v34, v64
    v_sub_f32 v35, v35, v64
    v_cvt_pk_bf16_f32 v76, v34, v35
    v_lshlrev_b32 v34, 16, v76
    v_and_b32 v35, 0xffff0000, v76
    v_mul_f32 v34, v34, v68
    v_mul_f32 v35, v35, v68
    v_cvt_pk_bf16_f32 v76, v34, v35
    ds_write_b16 v80, v76 offset:64
    ds_write_b16_d16_hi v80, v76 offset:96
    ds_write_b16 v80, v9 offset:17472
    ds_write_b16_d16_hi v80, v9 offset:17504
    v_sub_f32 v36, v36, v64
    v_sub_f32 v37, v37, v64
    v_cvt_pk_bf16_f32 v76, v36, v37
    v_lshlrev_b32 v36, 16, v76
    v_and_b32 v37, 0xffff0000, v76
    v_mul_f32 v36, v36, v68
    v_mul_f32 v37, v37, v68
    v_cvt_pk_bf16_f32 v76, v36, v37
    ds_write_b16 v80, v76 offset:128
    ds_write_b16_d16_hi v80, v76 offset:160
    ds_write_b16 v80, v10 offset:17536
    ds_write_b16_d16_hi v80, v10 offset:17568
    v_sub_f32 v38, v38, v64
    v_sub_f32 v39, v39, v64
    v_cvt_pk_bf16_f32 v76, v38, v39
    v_lshlrev_b32 v38, 16, v76
    v_and_b32 v39, 0xffff0000, v76
    v_mul_f32 v38, v38, v68
    v_mul_f32 v39, v39, v68
    v_cvt_pk_bf16_f32 v76, v38, v39
    ds_write_b16 v80, v76 offset:192
    ds_write_b16_d16_hi v80, v76 offset:224
    ds_write_b16 v80, v11 offset:17600
    ds_write_b16_d16_hi v80, v11 offset:17632
    v_mul_f32 v69, 0x3b000000, v69
    v_cvt_pk_bf16_f32 v65, v65, v65
    v_lshlrev_b32 v65, 16, v65
    v_cvt_pk_bf16_f32 v69, v69, v69
    v_lshlrev_b32 v69, 16, v69
    v_add_f32 v69, 0x3727c5ac, v69
    v_cvt_pk_bf16_f32 v69, v69, v69
    v_lshlrev_b32 v69, 16, v69
    v_sqrt_f32 v69, v69
    s_nop 0
    v_cvt_pk_bf16_f32 v69, v69, v69
    v_lshlrev_b32 v69, 16, v69
    v_rcp_f32 v69, v69
    s_nop 0
    v_sub_f32 v40, v40, v65
    v_sub_f32 v41, v41, v65
    v_cvt_pk_bf16_f32 v76, v40, v41
    v_lshlrev_b32 v40, 16, v76
    v_and_b32 v41, 0xffff0000, v76
    v_mul_f32 v40, v40, v69
    v_mul_f32 v41, v41, v69
    v_cvt_pk_bf16_f32 v76, v40, v41
    ds_write_b16 v80, v76 offset:2
    ds_write_b16_d16_hi v80, v76 offset:34
    ds_write_b16 v80, v12 offset:17410
    ds_write_b16_d16_hi v80, v12 offset:17442
    v_sub_f32 v42, v42, v65
    v_sub_f32 v43, v43, v65
    v_cvt_pk_bf16_f32 v76, v42, v43
    v_lshlrev_b32 v42, 16, v76
    v_and_b32 v43, 0xffff0000, v76
    v_mul_f32 v42, v42, v69
    v_mul_f32 v43, v43, v69
    v_cvt_pk_bf16_f32 v76, v42, v43
    ds_write_b16 v80, v76 offset:66
    ds_write_b16_d16_hi v80, v76 offset:98
    ds_write_b16 v80, v13 offset:17474
    ds_write_b16_d16_hi v80, v13 offset:17506
    v_sub_f32 v44, v44, v65
    v_sub_f32 v45, v45, v65
    v_cvt_pk_bf16_f32 v76, v44, v45
    v_lshlrev_b32 v44, 16, v76
    v_and_b32 v45, 0xffff0000, v76
    v_mul_f32 v44, v44, v69
    v_mul_f32 v45, v45, v69
    v_cvt_pk_bf16_f32 v76, v44, v45
    ds_write_b16 v80, v76 offset:130
    ds_write_b16_d16_hi v80, v76 offset:162
    ds_write_b16 v80, v14 offset:17538
    ds_write_b16_d16_hi v80, v14 offset:17570
    v_sub_f32 v46, v46, v65
    v_sub_f32 v47, v47, v65
    v_cvt_pk_bf16_f32 v76, v46, v47
    v_lshlrev_b32 v46, 16, v76
    v_and_b32 v47, 0xffff0000, v76
    v_mul_f32 v46, v46, v69
    v_mul_f32 v47, v47, v69
    v_cvt_pk_bf16_f32 v76, v46, v47
    ds_write_b16 v80, v76 offset:194
    ds_write_b16_d16_hi v80, v76 offset:226
    ds_write_b16 v80, v15 offset:17602
    ds_write_b16_d16_hi v80, v15 offset:17634
    v_mul_f32 v70, 0x3b000000, v70
    v_cvt_pk_bf16_f32 v66, v66, v66
    v_lshlrev_b32 v66, 16, v66
    v_cvt_pk_bf16_f32 v70, v70, v70
    v_lshlrev_b32 v70, 16, v70
    v_add_f32 v70, 0x3727c5ac, v70
    v_cvt_pk_bf16_f32 v70, v70, v70
    v_lshlrev_b32 v70, 16, v70
    v_sqrt_f32 v70, v70
    s_nop 0
    v_cvt_pk_bf16_f32 v70, v70, v70
    v_lshlrev_b32 v70, 16, v70
    v_rcp_f32 v70, v70
    s_nop 0
    v_sub_f32 v48, v48, v66
    v_sub_f32 v49, v49, v66
    v_cvt_pk_bf16_f32 v76, v48, v49
    v_lshlrev_b32 v48, 16, v76
    v_and_b32 v49, 0xffff0000, v76
    v_mul_f32 v48, v48, v70
    v_mul_f32 v49, v49, v70
    v_cvt_pk_bf16_f32 v76, v48, v49
    ds_write_b16 v80, v76 offset:4
    ds_write_b16_d16_hi v80, v76 offset:36
    ds_write_b16 v80, v16 offset:17412
    ds_write_b16_d16_hi v80, v16 offset:17444
    v_sub_f32 v50, v50, v66
    v_sub_f32 v51, v51, v66
    v_cvt_pk_bf16_f32 v76, v50, v51
    v_lshlrev_b32 v50, 16, v76
    v_and_b32 v51, 0xffff0000, v76
    v_mul_f32 v50, v50, v70
    v_mul_f32 v51, v51, v70
    v_cvt_pk_bf16_f32 v76, v50, v51
    ds_write_b16 v80, v76 offset:68
    ds_write_b16_d16_hi v80, v76 offset:100
    ds_write_b16 v80, v17 offset:17476
    ds_write_b16_d16_hi v80, v17 offset:17508
    v_sub_f32 v52, v52, v66
    v_sub_f32 v53, v53, v66
    v_cvt_pk_bf16_f32 v76, v52, v53
    v_lshlrev_b32 v52, 16, v76
    v_and_b32 v53, 0xffff0000, v76
    v_mul_f32 v52, v52, v70
    v_mul_f32 v53, v53, v70
    v_cvt_pk_bf16_f32 v76, v52, v53
    ds_write_b16 v80, v76 offset:132
    ds_write_b16_d16_hi v80, v76 offset:164
    ds_write_b16 v80, v18 offset:17540
    ds_write_b16_d16_hi v80, v18 offset:17572
    v_sub_f32 v54, v54, v66
    v_sub_f32 v55, v55, v66
    v_cvt_pk_bf16_f32 v76, v54, v55
    v_lshlrev_b32 v54, 16, v76
    v_and_b32 v55, 0xffff0000, v76
    v_mul_f32 v54, v54, v70
    v_mul_f32 v55, v55, v70
    v_cvt_pk_bf16_f32 v76, v54, v55
    ds_write_b16 v80, v76 offset:196
    ds_write_b16_d16_hi v80, v76 offset:228
    ds_write_b16 v80, v19 offset:17604
    ds_write_b16_d16_hi v80, v19 offset:17636
    v_mul_f32 v71, 0x3b000000, v71
    v_cvt_pk_bf16_f32 v67, v67, v67
    v_lshlrev_b32 v67, 16, v67
    v_cvt_pk_bf16_f32 v71, v71, v71
    v_lshlrev_b32 v71, 16, v71
    v_add_f32 v71, 0x3727c5ac, v71
    v_cvt_pk_bf16_f32 v71, v71, v71
    v_lshlrev_b32 v71, 16, v71
    v_sqrt_f32 v71, v71
    s_nop 0
    v_cvt_pk_bf16_f32 v71, v71, v71
    v_lshlrev_b32 v71, 16, v71
    v_rcp_f32 v71, v71
    s_nop 0
    v_sub_f32 v56, v56, v67
    v_sub_f32 v57, v57, v67
    v_cvt_pk_bf16_f32 v76, v56, v57
    v_lshlrev_b32 v56, 16, v76
    v_and_b32 v57, 0xffff0000, v76
    v_mul_f32 v56, v56, v71
    v_mul_f32 v57, v57, v71
    v_cvt_pk_bf16_f32 v76, v56, v57
    ds_write_b16 v80, v76 offset:6
    ds_write_b16_d16_hi v80, v76 offset:38
    ds_write_b16 v80, v20 offset:17414
    ds_write_b16_d16_hi v80, v20 offset:17446
    v_sub_f32 v58, v58, v67
    v_sub_f32 v59, v59, v67
    v_cvt_pk_bf16_f32 v76, v58, v59
    v_lshlrev_b32 v58, 16, v76
    v_and_b32 v59, 0xffff0000, v76
    v_mul_f32 v58, v58, v71
    v_mul_f32 v59, v59, v71
    v_cvt_pk_bf16_f32 v76, v58, v59
    ds_write_b16 v80, v76 offset:70
    ds_write_b16_d16_hi v80, v76 offset:102
    ds_write_b16 v80, v21 offset:17478
    ds_write_b16_d16_hi v80, v21 offset:17510
    v_sub_f32 v60, v60, v67
    v_sub_f32 v61, v61, v67
    v_cvt_pk_bf16_f32 v76, v60, v61
    v_lshlrev_b32 v60, 16, v76
    v_and_b32 v61, 0xffff0000, v76
    v_mul_f32 v60, v60, v71
    v_mul_f32 v61, v61, v71
    v_cvt_pk_bf16_f32 v76, v60, v61
    ds_write_b16 v80, v76 offset:134
    ds_write_b16_d16_hi v80, v76 offset:166
    ds_write_b16 v80, v22 offset:17542
    ds_write_b16_d16_hi v80, v22 offset:17574
    v_sub_f32 v62, v62, v67
    v_sub_f32 v63, v63, v67
    v_cvt_pk_bf16_f32 v76, v62, v63
    v_lshlrev_b32 v62, 16, v76
    v_and_b32 v63, 0xffff0000, v76
    v_mul_f32 v62, v62, v71
    v_mul_f32 v63, v63, v71
    v_cvt_pk_bf16_f32 v76, v62, v63
    ds_write_b16 v80, v76 offset:198
    ds_write_b16_d16_hi v80, v76 offset:230
    ds_write_b16 v80, v23 offset:17606
    ds_write_b16_d16_hi v80, v23 offset:17638
    s_waitcnt lgkmcnt(0)
    s_barrier
    s_lshl_b32 s21, s2, 5
    v_add_u32 v4, 0, v0
    v_lshrrev_b32 v5, 3, v4
    v_lshlrev_b32 v5, 4, v5
    v_lshl_add_u32 v5, v4, 5, v5
    v_lshlrev_b32 v6, 12, v4
    v_add_u32 v6, s21, v6
    ds_read_b128 v[8:11], v5
    ds_read_b128 v[12:15], v5 offset:16
    ds_read_b128 v[16:19], v5 offset:17408
    ds_read_b128 v[20:23], v5 offset:17424
    v_add_u32 v7, 2097152, v6
    s_waitcnt lgkmcnt(0)
    buffer_store_dwordx4 v[8:11], v6, s[16:19], 0 offen
    buffer_store_dwordx4 v[12:15], v6, s[16:19], 0 offen offset:16
    buffer_store_dwordx4 v[16:19], v7, s[16:19], 0 offen
    buffer_store_dwordx4 v[20:23], v7, s[16:19], 0 offen offset:16
    s_nop 1

    v_add_u32 v4, 256, v0
    v_lshrrev_b32 v5, 3, v4
    v_lshlrev_b32 v5, 4, v5
    v_lshl_add_u32 v5, v4, 5, v5
    v_lshlrev_b32 v6, 12, v4
    v_add_u32 v6, s21, v6
    ds_read_b128 v[8:11], v5
    ds_read_b128 v[12:15], v5 offset:16
    ds_read_b128 v[16:19], v5 offset:17408
    ds_read_b128 v[20:23], v5 offset:17424
    v_add_u32 v7, 2097152, v6
    s_waitcnt lgkmcnt(0)
    buffer_store_dwordx4 v[8:11], v6, s[16:19], 0 offen
    buffer_store_dwordx4 v[12:15], v6, s[16:19], 0 offen offset:16
    buffer_store_dwordx4 v[16:19], v7, s[16:19], 0 offen
    buffer_store_dwordx4 v[20:23], v7, s[16:19], 0 offen offset:16
    s_nop 1

    s_branch LA_done
LA_tr:
    s_sub_u32 s20, s2, 128
    s_cmp_ge_u32 s20, 224
    s_cbranch_scc1 LA_w2
    s_mov_b32 s21, 0x924924a
    s_mul_hi_u32 s22, s20, s21
    s_mul_i32 s23, s22, 28
    s_sub_u32 s23, s20, s23
    s_mov_b32 s24, 3584
    s_mov_b32 s25, 1024
    s_mov_b32 s26, 4194304
    s_mov_b32 s12, s8
    s_mov_b32 s13, s9
    s_mov_b32 s14, 1835008
    s_mov_b32 s15, 0x00020000
    s_branch LA_go
LA_w2:
    s_sub_u32 s20, s20, 224
    s_lshr_b32 s22, s20, 3
    s_and_b32 s23, s20, 7
    s_mov_b32 s24, 1024
    s_mov_b32 s25, 3584
    s_mov_b32 s26, 6291456
    s_mov_b32 s12, s10
    s_mov_b32 s13, s11
    s_mov_b32 s14, 1835008
    s_mov_b32 s15, 0x00020000
LA_go:
    s_lshl_b32 s27, s22, 6
    s_mul_i32 s28, s27, s24
    s_lshl_b32 s29, s23, 7
    s_add_u32 s28, s28, s29
    v_lshrrev_b32 v1, 3, v0
    v_and_b32 v2, 7, v0
    v_mul_lo_u32 v3, v1, s24
    v_lshl_add_u32 v3, v2, 4, v3
    v_add_u32 v3, s28, v3
    s_lshl_b32 s30, s24, 5
    v_add_u32 v4, s30, v3
    buffer_load_dwordx4 v[8:11], v3, s[12:15], 0 offen
    buffer_load_dwordx4 v[12:15], v4, s[12:15], 0 offen
    v_mul_u32_u24 v5, 144, v1
    v_lshl_add_u32 v5, v2, 4, v5
    s_waitcnt vmcnt(0)
    ds_write_b128 v5, v[8:11]
    ds_write_b128 v5, v[12:15] offset:4608
    s_waitcnt lgkmcnt(0)
    s_barrier
    v_lshrrev_b32 v1, 2, v0
    v_and_b32 v2, 3, v0
    v_mul_u32_u24 v5, 2304, v2
    v_lshl_add_u32 v5, v1, 1, v5

    ds_read_u16 v16, v5 offset:0
    ds_read_u16 v17, v5 offset:144
    ds_read_u16 v18, v5 offset:288
    ds_read_u16 v19, v5 offset:432
    ds_read_u16 v20, v5 offset:576
    ds_read_u16 v21, v5 offset:720
    ds_read_u16 v22, v5 offset:864
    ds_read_u16 v23, v5 offset:1008
    ds_read_u16 v24, v5 offset:1152
    ds_read_u16 v25, v5 offset:1296
    ds_read_u16 v26, v5 offset:1440
    ds_read_u16 v27, v5 offset:1584
    ds_read_u16 v28, v5 offset:1728
    ds_read_u16 v29, v5 offset:1872
    ds_read_u16 v30, v5 offset:2016
    ds_read_u16 v31, v5 offset:2160
    s_waitcnt lgkmcnt(0)
    v_lshl_or_b32 v8, v17, 16, v16
    v_lshl_or_b32 v9, v19, 16, v18
    v_lshl_or_b32 v10, v21, 16, v20
    v_lshl_or_b32 v11, v23, 16, v22
    v_lshl_or_b32 v12, v25, 16, v24
    v_lshl_or_b32 v13, v27, 16, v26
    v_lshl_or_b32 v14, v29, 16, v28
    v_lshl_or_b32 v15, v31, 16, v30
    s_lshl_b32 s29, s23, 6
    v_add_u32 v6, s29, v1
    v_mul_lo_u32 v6, v6, s25
    v_lshl_add_u32 v6, v2, 5, v6
    s_lshl_b32 s27, s22, 7
    s_add_u32 s27, s27, s26
    v_add_u32 v6, s27, v6
    s_waitcnt lgkmcnt(0)
    buffer_store_dwordx4 v[8:11], v6, s[16:19], 0 offen
    buffer_store_dwordx4 v[12:15], v6, s[16:19], 0 offen offset:16

LA_done:
    s_endpgm
.section .rodata,"a"
.p2align 6
.amdhsa_kernel lnt_kernel
  .amdhsa_next_free_vgpr 96
  .amdhsa_next_free_sgpr 102
  .amdhsa_accum_offset 96
  .amdhsa_group_segment_fixed_size 0
  .amdhsa_kernarg_size 120
  .amdhsa_user_sgpr_count 2
  .amdhsa_user_sgpr_kernarg_segment_ptr 1
  .amdhsa_system_sgpr_workgroup_id_x 1
.end_amdhsa_kernel
.text
.p2align 8
conv_kernel:
    s_cmp_ge_u32 s2, 256
    s_cbranch_scc1 LB_done
    s_load_dwordx16 s[4:19], s[0:1], 8
    s_load_dwordx2 s[20:21], s[0:1], 112
    s_waitcnt lgkmcnt(0)
    v_and_b32 v1, 63, v0
    v_lshrrev_b32 v2, 6, v0
    s_nop 1
    v_readfirstlane_b32 s44, v2
    s_cmp_ge_u32 s44, 4
    s_cbranch_scc1 LB_s1
    s_lshl_b32 s22, s2, 9
    v_lshlrev_b32 v3, 1, v0
    v_add_u32 v3, s22, v3

    s_mov_b32 s24, s4
    s_mov_b32 s25, s5
    s_mov_b32 s26, 131072
    s_mov_b32 s27, 0x00020000
    buffer_load_ushort v8, v3, s[24:27], 0 offen
    s_mov_b32 s24, s6
    s_mov_b32 s25, s7
    s_mov_b32 s26, 131072
    s_mov_b32 s27, 0x00020000
    buffer_load_ushort v9, v3, s[24:27], 0 offen
    s_mov_b32 s24, s8
    s_mov_b32 s25, s9
    s_mov_b32 s26, 131072
    s_mov_b32 s27, 0x00020000
    buffer_load_ushort v10, v3, s[24:27], 0 offen
    s_mov_b32 s24, s10
    s_mov_b32 s25, s11
    s_mov_b32 s26, 131072
    s_mov_b32 s27, 0x00020000
    buffer_load_ushort v11, v3, s[24:27], 0 offen
    s_mov_b32 s24, s12
    s_mov_b32 s25, s13
    s_mov_b32 s26, 131072
    s_mov_b32 s27, 0x00020000
    buffer_load_ushort v12, v3, s[24:27], 0 offen
    s_mov_b32 s24, s14
    s_mov_b32 s25, s15
    s_mov_b32 s26, 131072
    s_mov_b32 s27, 0x00020000
    buffer_load_ushort v13, v3, s[24:27], 0 offen
    s_mov_b32 s28, s16
    s_mov_b32 s29, s17
    s_mov_b32 s30, 1024
    s_mov_b32 s31, 0x00020000
    s_mov_b32 s32, s18
    s_mov_b32 s33, s19
    s_mov_b32 s34, 1024
    s_mov_b32 s35, 0x00020000
    s_mov_b32 s36, s20
    s_mov_b32 s37, s21
    s_mov_b32 s38, 33554432
    s_mov_b32 s39, 0x00020000
    v_lshrrev_b32 v4, 7, v0
    s_lshl_b32 s23, s2, 2
    v_lshl_add_u32 v4, v4, 1, s23
    buffer_load_ushort v14, v4, s[28:31], 0 offen
    s_waitcnt vmcnt(0)
    v_lshlrev_b32 v8, 16, v8
    v_lshlrev_b32 v9, 16, v9
    v_lshlrev_b32 v10, 16, v10
    v_lshlrev_b32 v11, 16, v11
    v_lshlrev_b32 v12, 16, v12
    v_lshlrev_b32 v13, 16, v13
    v_lshlrev_b32 v14, 16, v14
    v_mul_f32 v14, 0x3fb8aa3b, v14
    v_exp_f32 v14, v14
    s_nop 0

    v_cvt_pk_bf16_f32 v14, v14, v14
    v_lshlrev_b32 v14, 16, v14
    v_mul_f32 v8, v14, v8
    v_mul_f32 v9, v14, v9
    v_mul_f32 v10, v14, v10
    v_mul_f32 v11, v14, v11
    v_mul_f32 v16, 0x3fb8aa3b, v8
    v_mul_f32 v17, 0.15915494, v9
    v_mul_f32 v18, v12, v10
    v_fma_f32 v18, -v13, v11, v18
    v_mul_f32 v19, v12, v11
    v_fmac_f32 v19, v13, v10
    v_lshlrev_b32 v5, 4, v0
    ds_write_b128 v5, v[16:19]

    v_mov_b32 v8, 0
    v_mov_b32 v9, 0
    v_mov_b32 v10, 0
    v_mov_b32 v11, 0
    v_add_u32 v6, 0, v0
    v_cmp_gt_u32 vcc, 1896, v6
    s_and_saveexec_b64 s[40:41], vcc
    v_lshlrev_b32 v6, 4, v6
    ds_write_b128 v6, v[8:11] offset:20480
    s_mov_b64 exec, s[40:41]
    v_add_u32 v6, 256, v0
    v_cmp_gt_u32 vcc, 1896, v6
    s_and_saveexec_b64 s[40:41], vcc
    v_lshlrev_b32 v6, 4, v6
    ds_write_b128 v6, v[8:11] offset:20480
    s_mov_b64 exec, s[40:41]
    v_add_u32 v6, 512, v0
    v_cmp_gt_u32 vcc, 1896, v6
    s_and_saveexec_b64 s[40:41], vcc
    v_lshlrev_b32 v6, 4, v6
    ds_write_b128 v6, v[8:11] offset:20480
    s_mov_b64 exec, s[40:41]
    v_add_u32 v6, 768, v0
    v_cmp_gt_u32 vcc, 1896, v6
    s_and_saveexec_b64 s[40:41], vcc
    v_lshlrev_b32 v6, 4, v6
    ds_write_b128 v6, v[8:11] offset:20480
    s_mov_b64 exec, s[40:41]
    v_add_u32 v6, 1024, v0
    v_cmp_gt_u32 vcc, 1896, v6
    s_and_saveexec_b64 s[40:41], vcc
    v_lshlrev_b32 v6, 4, v6
    ds_write_b128 v6, v[8:11] offset:20480
    s_mov_b64 exec, s[40:41]
    v_add_u32 v6, 1280, v0
    v_cmp_gt_u32 vcc, 1896, v6
    s_and_saveexec_b64 s[40:41], vcc
    v_lshlrev_b32 v6, 4, v6
    ds_write_b128 v6, v[8:11] offset:20480
    s_mov_b64 exec, s[40:41]
    v_add_u32 v6, 1536, v0
    v_cmp_gt_u32 vcc, 1896, v6
    s_and_saveexec_b64 s[40:41], vcc
    v_lshlrev_b32 v6, 4, v6
    ds_write_b128 v6, v[8:11] offset:20480
    s_mov_b64 exec, s[40:41]
    v_add_u32 v6, 1792, v0
    v_cmp_gt_u32 vcc, 1896, v6
    s_and_saveexec_b64 s[40:41], vcc
    v_lshlrev_b32 v6, 4, v6
    ds_write_b128 v6, v[8:11] offset:20480
    s_mov_b64 exec, s[40:41]
    s_waitcnt lgkmcnt(0)
LB_s1:
    s_mov_b32 s32, s18
    s_mov_b32 s33, s19
    s_mov_b32 s34, 1024
    s_mov_b32 s35, 0x00020000
    s_mov_b32 s36, s20
    s_mov_b32 s37, s21
    s_mov_b32 s38, 33554432
    s_mov_b32 s39, 0x00020000
    s_barrier
    s_cmp_ge_u32 s44, 4
    s_cbranch_scc1 LB_s2
    s_lshl_b32 s23, s2, 13
    v_lshlrev_b32 v6, 5, v0
    v_add_u32 v6, s23, v6
    buffer_load_dwordx4 v[8:11], v6, s[36:39], 0 offen
    buffer_load_dwordx4 v[12:15], v6, s[36:39], 0 offen offset:16
    v_lshrrev_b32 v7, 7, v0
    v_mul_u32_u24 v7, 4672, v7
    v_and_b32 v6, 127, v0
    v_lshl_add_u32 v7, v6, 5, v7
    s_waitcnt vmcnt(0)
    ds_write_b128 v7, v[8:11] offset:41472
    ds_write_b128 v7, v[12:15] offset:41488

LB_s2:
    v_and_b32 v3, 15, v1
    v_cvt_f32_u32 v4, v3
    v_lshrrev_b32 v5, 4, v1
    v_lshrrev_b32 v6, 2, v2
    v_and_b32 v7, 3, v2
    v_lshlrev_b32 v20, 11, v6
    v_lshl_add_u32 v20, v7, 9, v20
    v_lshl_add_u32 v20, v5, 6, v20

    v_mov_b32 v24, 0.0
    v_fmac_f32 v24, 16.0, v4
    v_mov_b32 v96, 0
    v_mov_b32 v97, 0
    v_mov_b32 v98, 0
    v_mov_b32 v99, 0
    v_mov_b32 v25, 256.0
    v_fmac_f32 v25, 32.0, v4
    v_mov_b32 v100, 0
    v_mov_b32 v101, 0
    v_mov_b32 v102, 0
    v_mov_b32 v103, 0
    v_mov_b32 v26, 512.0
    v_fmac_f32 v26, 64.0, v4
    v_mov_b32 v104, 0
    v_mov_b32 v105, 0
    v_mov_b32 v106, 0
    v_mov_b32 v107, 0
    v_mov_b32 v27, 1024.0
    v_fmac_f32 v27, 128.0, v4
    v_mov_b32 v108, 0
    v_mov_b32 v109, 0
    v_mov_b32 v110, 0
    v_mov_b32 v111, 0
    ds_read_b128 v[8:11], v20 offset:0
    s_waitcnt lgkmcnt(0)
    v_mul_f32 v12, v8, v4
    v_mul_f32 v13, v9, v4
    v_exp_f32 v12, v12
    v_fract_f32 v13, v13
    s_nop 0
    v_cos_f32 v14, v13
    v_sin_f32 v15, v13
    s_nop 0
    v_mul_f32 v14, v14, v12
    v_mul_f32 v15, v15, v12

    v_cvt_pk_bf16_f32 v32, v14, v15
    v_lshlrev_b32 v18, 16, v32
    v_and_b32 v19, 0xffff0000, v32
    v_sub_f32 v18, v14, v18
    v_sub_f32 v19, v15, v19
    v_cvt_pk_bf16_f32 v36, v18, v19

    v_mul_f32 v16, v15, v15
    v_mul_f32 v17, v14, v15
    v_fma_f32 v14, v14, v14, -v16
    v_add_f32 v15, v17, v17

    v_cvt_pk_bf16_f32 v40, v14, v15
    v_lshlrev_b32 v18, 16, v40
    v_and_b32 v19, 0xffff0000, v40
    v_sub_f32 v18, v14, v18
    v_sub_f32 v19, v15, v19
    v_cvt_pk_bf16_f32 v44, v18, v19

    v_mul_f32 v16, v15, v15
    v_mul_f32 v17, v14, v15
    v_fma_f32 v14, v14, v14, -v16
    v_add_f32 v15, v17, v17

    v_cvt_pk_bf16_f32 v48, v14, v15
    v_lshlrev_b32 v18, 16, v48
    v_and_b32 v19, 0xffff0000, v48
    v_sub_f32 v18, v14, v18
    v_sub_f32 v19, v15, v19
    v_cvt_pk_bf16_f32 v52, v18, v19

    v_mul_f32 v16, v15, v15
    v_mul_f32 v17, v14, v15
    v_fma_f32 v14, v14, v14, -v16
    v_add_f32 v15, v17, v17

    v_cvt_pk_bf16_f32 v56, v14, v15
    v_lshlrev_b32 v18, 16, v56
    v_and_b32 v19, 0xffff0000, v56
    v_sub_f32 v18, v14, v18
    v_sub_f32 v19, v15, v19
    v_cvt_pk_bf16_f32 v60, v18, v19

    v_mul_f32 v12, v8, v24
    v_mul_f32 v13, v9, v24
    v_exp_f32 v12, v12
    v_fract_f32 v13, v13
    s_nop 0
    v_cos_f32 v14, v13
    v_sin_f32 v15, v13
    s_nop 0
    v_mul_f32 v14, v14, v12
    v_mul_f32 v15, v15, v12

    v_mul_f32 v16, v10, v14
    v_fma_f32 v16, -v11, v15, v16
    v_mul_f32 v17, v10, v15
    v_fmac_f32 v17, v11, v14
    v_sub_f32 v17, 0, v17

    v_cvt_pk_bf16_f32 v64, v16, v17
    v_lshlrev_b32 v18, 16, v64
    v_and_b32 v19, 0xffff0000, v64
    v_sub_f32 v18, v16, v18
    v_sub_f32 v19, v17, v19
    v_cvt_pk_bf16_f32 v68, v18, v19

    v_mul_f32 v12, v8, v25
    v_mul_f32 v13, v9, v25
    v_exp_f32 v12, v12
    v_fract_f32 v13, v13
    s_nop 0
    v_cos_f32 v14, v13
    v_sin_f32 v15, v13
    s_nop 0
    v_mul_f32 v14, v14, v12
    v_mul_f32 v15, v15, v12

    v_mul_f32 v16, v10, v14
    v_fma_f32 v16, -v11, v15, v16
    v_mul_f32 v17, v10, v15
    v_fmac_f32 v17, v11, v14
    v_sub_f32 v17, 0, v17

    v_cvt_pk_bf16_f32 v72, v16, v17
    v_lshlrev_b32 v18, 16, v72
    v_and_b32 v19, 0xffff0000, v72
    v_sub_f32 v18, v16, v18
    v_sub_f32 v19, v17, v19
    v_cvt_pk_bf16_f32 v76, v18, v19

    v_mul_f32 v16, v15, v15
    v_mul_f32 v17, v14, v15
    v_fma_f32 v14, v14, v14, -v16
    v_add_f32 v15, v17, v17

    v_mul_f32 v16, v10, v14
    v_fma_f32 v16, -v11, v15, v16
    v_mul_f32 v17, v10, v15
    v_fmac_f32 v17, v11, v14
    v_sub_f32 v17, 0, v17

    v_cvt_pk_bf16_f32 v80, v16, v17
    v_lshlrev_b32 v18, 16, v80
    v_and_b32 v19, 0xffff0000, v80
    v_sub_f32 v18, v16, v18
    v_sub_f32 v19, v17, v19
    v_cvt_pk_bf16_f32 v84, v18, v19

    v_mul_f32 v16, v15, v15
    v_mul_f32 v17, v14, v15
    v_fma_f32 v14, v14, v14, -v16
    v_add_f32 v15, v17, v17

    v_mul_f32 v16, v10, v14
    v_fma_f32 v16, -v11, v15, v16
    v_mul_f32 v17, v10, v15
    v_fmac_f32 v17, v11, v14
    v_sub_f32 v17, 0, v17

    v_cvt_pk_bf16_f32 v88, v16, v17
    v_lshlrev_b32 v18, 16, v88
    v_and_b32 v19, 0xffff0000, v88
    v_sub_f32 v18, v16, v18
    v_sub_f32 v19, v17, v19
    v_cvt_pk_bf16_f32 v92, v18, v19

    ds_read_b128 v[8:11], v20 offset:16
    s_waitcnt lgkmcnt(0)
    v_mul_f32 v12, v8, v4
    v_mul_f32 v13, v9, v4
    v_exp_f32 v12, v12
    v_fract_f32 v13, v13
    s_nop 0
    v_cos_f32 v14, v13
    v_sin_f32 v15, v13
    s_nop 0
    v_mul_f32 v14, v14, v12
    v_mul_f32 v15, v15, v12

    v_cvt_pk_bf16_f32 v33, v14, v15
    v_lshlrev_b32 v18, 16, v33
    v_and_b32 v19, 0xffff0000, v33
    v_sub_f32 v18, v14, v18
    v_sub_f32 v19, v15, v19
    v_cvt_pk_bf16_f32 v37, v18, v19

    v_mul_f32 v16, v15, v15
    v_mul_f32 v17, v14, v15
    v_fma_f32 v14, v14, v14, -v16
    v_add_f32 v15, v17, v17

    v_cvt_pk_bf16_f32 v41, v14, v15
    v_lshlrev_b32 v18, 16, v41
    v_and_b32 v19, 0xffff0000, v41
    v_sub_f32 v18, v14, v18
    v_sub_f32 v19, v15, v19
    v_cvt_pk_bf16_f32 v45, v18, v19

    v_mul_f32 v16, v15, v15
    v_mul_f32 v17, v14, v15
    v_fma_f32 v14, v14, v14, -v16
    v_add_f32 v15, v17, v17

    v_cvt_pk_bf16_f32 v49, v14, v15
    v_lshlrev_b32 v18, 16, v49
    v_and_b32 v19, 0xffff0000, v49
    v_sub_f32 v18, v14, v18
    v_sub_f32 v19, v15, v19
    v_cvt_pk_bf16_f32 v53, v18, v19

    v_mul_f32 v16, v15, v15
    v_mul_f32 v17, v14, v15
    v_fma_f32 v14, v14, v14, -v16
    v_add_f32 v15, v17, v17

    v_cvt_pk_bf16_f32 v57, v14, v15
    v_lshlrev_b32 v18, 16, v57
    v_and_b32 v19, 0xffff0000, v57
    v_sub_f32 v18, v14, v18
    v_sub_f32 v19, v15, v19
    v_cvt_pk_bf16_f32 v61, v18, v19

    v_mul_f32 v12, v8, v24
    v_mul_f32 v13, v9, v24
    v_exp_f32 v12, v12
    v_fract_f32 v13, v13
    s_nop 0
    v_cos_f32 v14, v13
    v_sin_f32 v15, v13
    s_nop 0
    v_mul_f32 v14, v14, v12
    v_mul_f32 v15, v15, v12

    v_mul_f32 v16, v10, v14
    v_fma_f32 v16, -v11, v15, v16
    v_mul_f32 v17, v10, v15
    v_fmac_f32 v17, v11, v14
    v_sub_f32 v17, 0, v17

    v_cvt_pk_bf16_f32 v65, v16, v17
    v_lshlrev_b32 v18, 16, v65
    v_and_b32 v19, 0xffff0000, v65
    v_sub_f32 v18, v16, v18
    v_sub_f32 v19, v17, v19
    v_cvt_pk_bf16_f32 v69, v18, v19

    v_mul_f32 v12, v8, v25
    v_mul_f32 v13, v9, v25
    v_exp_f32 v12, v12
    v_fract_f32 v13, v13
    s_nop 0
    v_cos_f32 v14, v13
    v_sin_f32 v15, v13
    s_nop 0
    v_mul_f32 v14, v14, v12
    v_mul_f32 v15, v15, v12

    v_mul_f32 v16, v10, v14
    v_fma_f32 v16, -v11, v15, v16
    v_mul_f32 v17, v10, v15
    v_fmac_f32 v17, v11, v14
    v_sub_f32 v17, 0, v17

    v_cvt_pk_bf16_f32 v73, v16, v17
    v_lshlrev_b32 v18, 16, v73
    v_and_b32 v19, 0xffff0000, v73
    v_sub_f32 v18, v16, v18
    v_sub_f32 v19, v17, v19
    v_cvt_pk_bf16_f32 v77, v18, v19

    v_mul_f32 v16, v15, v15
    v_mul_f32 v17, v14, v15
    v_fma_f32 v14, v14, v14, -v16
    v_add_f32 v15, v17, v17

    v_mul_f32 v16, v10, v14
    v_fma_f32 v16, -v11, v15, v16
    v_mul_f32 v17, v10, v15
    v_fmac_f32 v17, v11, v14
    v_sub_f32 v17, 0, v17

    v_cvt_pk_bf16_f32 v81, v16, v17
    v_lshlrev_b32 v18, 16, v81
    v_and_b32 v19, 0xffff0000, v81
    v_sub_f32 v18, v16, v18
    v_sub_f32 v19, v17, v19
    v_cvt_pk_bf16_f32 v85, v18, v19

    v_mul_f32 v16, v15, v15
    v_mul_f32 v17, v14, v15
    v_fma_f32 v14, v14, v14, -v16
    v_add_f32 v15, v17, v17

    v_mul_f32 v16, v10, v14
    v_fma_f32 v16, -v11, v15, v16
    v_mul_f32 v17, v10, v15
    v_fmac_f32 v17, v11, v14
    v_sub_f32 v17, 0, v17

    v_cvt_pk_bf16_f32 v89, v16, v17
    v_lshlrev_b32 v18, 16, v89
    v_and_b32 v19, 0xffff0000, v89
    v_sub_f32 v18, v16, v18
    v_sub_f32 v19, v17, v19
    v_cvt_pk_bf16_f32 v93, v18, v19

    ds_read_b128 v[8:11], v20 offset:32
    s_waitcnt lgkmcnt(0)
    v_mul_f32 v12, v8, v4
    v_mul_f32 v13, v9, v4
    v_exp_f32 v12, v12
    v_fract_f32 v13, v13
    s_nop 0
    v_cos_f32 v14, v13
    v_sin_f32 v15, v13
    s_nop 0
    v_mul_f32 v14, v14, v12
    v_mul_f32 v15, v15, v12

    v_cvt_pk_bf16_f32 v34, v14, v15
    v_lshlrev_b32 v18, 16, v34
    v_and_b32 v19, 0xffff0000, v34
    v_sub_f32 v18, v14, v18
    v_sub_f32 v19, v15, v19
    v_cvt_pk_bf16_f32 v38, v18, v19

    v_mul_f32 v16, v15, v15
    v_mul_f32 v17, v14, v15
    v_fma_f32 v14, v14, v14, -v16
    v_add_f32 v15, v17, v17

    v_cvt_pk_bf16_f32 v42, v14, v15
    v_lshlrev_b32 v18, 16, v42
    v_and_b32 v19, 0xffff0000, v42
    v_sub_f32 v18, v14, v18
    v_sub_f32 v19, v15, v19
    v_cvt_pk_bf16_f32 v46, v18, v19

    v_mul_f32 v16, v15, v15
    v_mul_f32 v17, v14, v15
    v_fma_f32 v14, v14, v14, -v16
    v_add_f32 v15, v17, v17

    v_cvt_pk_bf16_f32 v50, v14, v15
    v_lshlrev_b32 v18, 16, v50
    v_and_b32 v19, 0xffff0000, v50
    v_sub_f32 v18, v14, v18
    v_sub_f32 v19, v15, v19
    v_cvt_pk_bf16_f32 v54, v18, v19

    v_mul_f32 v16, v15, v15
    v_mul_f32 v17, v14, v15
    v_fma_f32 v14, v14, v14, -v16
    v_add_f32 v15, v17, v17

    v_cvt_pk_bf16_f32 v58, v14, v15
    v_lshlrev_b32 v18, 16, v58
    v_and_b32 v19, 0xffff0000, v58
    v_sub_f32 v18, v14, v18
    v_sub_f32 v19, v15, v19
    v_cvt_pk_bf16_f32 v62, v18, v19

    v_mul_f32 v12, v8, v24
    v_mul_f32 v13, v9, v24
    v_exp_f32 v12, v12
    v_fract_f32 v13, v13
    s_nop 0
    v_cos_f32 v14, v13
    v_sin_f32 v15, v13
    s_nop 0
    v_mul_f32 v14, v14, v12
    v_mul_f32 v15, v15, v12

    v_mul_f32 v16, v10, v14
    v_fma_f32 v16, -v11, v15, v16
    v_mul_f32 v17, v10, v15
    v_fmac_f32 v17, v11, v14
    v_sub_f32 v17, 0, v17

    v_cvt_pk_bf16_f32 v66, v16, v17
    v_lshlrev_b32 v18, 16, v66
    v_and_b32 v19, 0xffff0000, v66
    v_sub_f32 v18, v16, v18
    v_sub_f32 v19, v17, v19
    v_cvt_pk_bf16_f32 v70, v18, v19

    v_mul_f32 v12, v8, v25
    v_mul_f32 v13, v9, v25
    v_exp_f32 v12, v12
    v_fract_f32 v13, v13
    s_nop 0
    v_cos_f32 v14, v13
    v_sin_f32 v15, v13
    s_nop 0
    v_mul_f32 v14, v14, v12
    v_mul_f32 v15, v15, v12

    v_mul_f32 v16, v10, v14
    v_fma_f32 v16, -v11, v15, v16
    v_mul_f32 v17, v10, v15
    v_fmac_f32 v17, v11, v14
    v_sub_f32 v17, 0, v17

    v_cvt_pk_bf16_f32 v74, v16, v17
    v_lshlrev_b32 v18, 16, v74
    v_and_b32 v19, 0xffff0000, v74
    v_sub_f32 v18, v16, v18
    v_sub_f32 v19, v17, v19
    v_cvt_pk_bf16_f32 v78, v18, v19

    v_mul_f32 v16, v15, v15
    v_mul_f32 v17, v14, v15
    v_fma_f32 v14, v14, v14, -v16
    v_add_f32 v15, v17, v17

    v_mul_f32 v16, v10, v14
    v_fma_f32 v16, -v11, v15, v16
    v_mul_f32 v17, v10, v15
    v_fmac_f32 v17, v11, v14
    v_sub_f32 v17, 0, v17

    v_cvt_pk_bf16_f32 v82, v16, v17
    v_lshlrev_b32 v18, 16, v82
    v_and_b32 v19, 0xffff0000, v82
    v_sub_f32 v18, v16, v18
    v_sub_f32 v19, v17, v19
    v_cvt_pk_bf16_f32 v86, v18, v19

    v_mul_f32 v16, v15, v15
    v_mul_f32 v17, v14, v15
    v_fma_f32 v14, v14, v14, -v16
    v_add_f32 v15, v17, v17

    v_mul_f32 v16, v10, v14
    v_fma_f32 v16, -v11, v15, v16
    v_mul_f32 v17, v10, v15
    v_fmac_f32 v17, v11, v14
    v_sub_f32 v17, 0, v17

    v_cvt_pk_bf16_f32 v90, v16, v17
    v_lshlrev_b32 v18, 16, v90
    v_and_b32 v19, 0xffff0000, v90
    v_sub_f32 v18, v16, v18
    v_sub_f32 v19, v17, v19
    v_cvt_pk_bf16_f32 v94, v18, v19

    ds_read_b128 v[8:11], v20 offset:48
    s_waitcnt lgkmcnt(0)
    v_mul_f32 v12, v8, v4
    v_mul_f32 v13, v9, v4
    v_exp_f32 v12, v12
    v_fract_f32 v13, v13
    s_nop 0
    v_cos_f32 v14, v13
    v_sin_f32 v15, v13
    s_nop 0
    v_mul_f32 v14, v14, v12
    v_mul_f32 v15, v15, v12

    v_cvt_pk_bf16_f32 v35, v14, v15
    v_lshlrev_b32 v18, 16, v35
    v_and_b32 v19, 0xffff0000, v35
    v_sub_f32 v18, v14, v18
    v_sub_f32 v19, v15, v19
    v_cvt_pk_bf16_f32 v39, v18, v19

    v_mul_f32 v16, v15, v15
    v_mul_f32 v17, v14, v15
    v_fma_f32 v14, v14, v14, -v16
    v_add_f32 v15, v17, v17

    v_cvt_pk_bf16_f32 v43, v14, v15
    v_lshlrev_b32 v18, 16, v43
    v_and_b32 v19, 0xffff0000, v43
    v_sub_f32 v18, v14, v18
    v_sub_f32 v19, v15, v19
    v_cvt_pk_bf16_f32 v47, v18, v19

    v_mul_f32 v16, v15, v15
    v_mul_f32 v17, v14, v15
    v_fma_f32 v14, v14, v14, -v16
    v_add_f32 v15, v17, v17

    v_cvt_pk_bf16_f32 v51, v14, v15
    v_lshlrev_b32 v18, 16, v51
    v_and_b32 v19, 0xffff0000, v51
    v_sub_f32 v18, v14, v18
    v_sub_f32 v19, v15, v19
    v_cvt_pk_bf16_f32 v55, v18, v19

    v_mul_f32 v16, v15, v15
    v_mul_f32 v17, v14, v15
    v_fma_f32 v14, v14, v14, -v16
    v_add_f32 v15, v17, v17

    v_cvt_pk_bf16_f32 v59, v14, v15
    v_lshlrev_b32 v18, 16, v59
    v_and_b32 v19, 0xffff0000, v59
    v_sub_f32 v18, v14, v18
    v_sub_f32 v19, v15, v19
    v_cvt_pk_bf16_f32 v63, v18, v19

    v_mul_f32 v12, v8, v24
    v_mul_f32 v13, v9, v24
    v_exp_f32 v12, v12
    v_fract_f32 v13, v13
    s_nop 0
    v_cos_f32 v14, v13
    v_sin_f32 v15, v13
    s_nop 0
    v_mul_f32 v14, v14, v12
    v_mul_f32 v15, v15, v12

    v_mul_f32 v16, v10, v14
    v_fma_f32 v16, -v11, v15, v16
    v_mul_f32 v17, v10, v15
    v_fmac_f32 v17, v11, v14
    v_sub_f32 v17, 0, v17

    v_cvt_pk_bf16_f32 v67, v16, v17
    v_lshlrev_b32 v18, 16, v67
    v_and_b32 v19, 0xffff0000, v67
    v_sub_f32 v18, v16, v18
    v_sub_f32 v19, v17, v19
    v_cvt_pk_bf16_f32 v71, v18, v19

    v_mul_f32 v12, v8, v25
    v_mul_f32 v13, v9, v25
    v_exp_f32 v12, v12
    v_fract_f32 v13, v13
    s_nop 0
    v_cos_f32 v14, v13
    v_sin_f32 v15, v13
    s_nop 0
    v_mul_f32 v14, v14, v12
    v_mul_f32 v15, v15, v12

    v_mul_f32 v16, v10, v14
    v_fma_f32 v16, -v11, v15, v16
    v_mul_f32 v17, v10, v15
    v_fmac_f32 v17, v11, v14
    v_sub_f32 v17, 0, v17

    v_cvt_pk_bf16_f32 v75, v16, v17
    v_lshlrev_b32 v18, 16, v75
    v_and_b32 v19, 0xffff0000, v75
    v_sub_f32 v18, v16, v18
    v_sub_f32 v19, v17, v19
    v_cvt_pk_bf16_f32 v79, v18, v19

    v_mul_f32 v16, v15, v15
    v_mul_f32 v17, v14, v15
    v_fma_f32 v14, v14, v14, -v16
    v_add_f32 v15, v17, v17

    v_mul_f32 v16, v10, v14
    v_fma_f32 v16, -v11, v15, v16
    v_mul_f32 v17, v10, v15
    v_fmac_f32 v17, v11, v14
    v_sub_f32 v17, 0, v17

    v_cvt_pk_bf16_f32 v83, v16, v17
    v_lshlrev_b32 v18, 16, v83
    v_and_b32 v19, 0xffff0000, v83
    v_sub_f32 v18, v16, v18
    v_sub_f32 v19, v17, v19
    v_cvt_pk_bf16_f32 v87, v18, v19

    v_mul_f32 v16, v15, v15
    v_mul_f32 v17, v14, v15
    v_fma_f32 v14, v14, v14, -v16
    v_add_f32 v15, v17, v17

    v_mul_f32 v16, v10, v14
    v_fma_f32 v16, -v11, v15, v16
    v_mul_f32 v17, v10, v15
    v_fmac_f32 v17, v11, v14
    v_sub_f32 v17, 0, v17

    v_cvt_pk_bf16_f32 v91, v16, v17
    v_lshlrev_b32 v18, 16, v91
    v_and_b32 v19, 0xffff0000, v91
    v_sub_f32 v18, v16, v18
    v_sub_f32 v19, v17, v19
    v_cvt_pk_bf16_f32 v95, v18, v19

    s_nop 1
    v_mfma_f32_16x16x32_bf16 v[96:99], v[64:67], v[32:35], v[96:99]
    v_mfma_f32_16x16x32_bf16 v[96:99], v[64:67], v[36:39], v[96:99]
    v_mfma_f32_16x16x32_bf16 v[96:99], v[68:71], v[32:35], v[96:99]
    v_mfma_f32_16x16x32_bf16 v[100:103], v[72:75], v[40:43], v[100:103]
    v_mfma_f32_16x16x32_bf16 v[100:103], v[72:75], v[44:47], v[100:103]
    v_mfma_f32_16x16x32_bf16 v[100:103], v[76:79], v[40:43], v[100:103]
    v_mfma_f32_16x16x32_bf16 v[104:107], v[80:83], v[48:51], v[104:107]
    v_mfma_f32_16x16x32_bf16 v[104:107], v[80:83], v[52:55], v[104:107]
    v_mfma_f32_16x16x32_bf16 v[104:107], v[84:87], v[48:51], v[104:107]
    v_mfma_f32_16x16x32_bf16 v[108:111], v[88:91], v[56:59], v[108:111]
    v_mfma_f32_16x16x32_bf16 v[108:111], v[88:91], v[60:63], v[108:111]
    v_mfma_f32_16x16x32_bf16 v[108:111], v[92:95], v[56:59], v[108:111]
    ds_read_b128 v[8:11], v20 offset:256
    s_waitcnt lgkmcnt(0)
    v_mul_f32 v12, v8, v4
    v_mul_f32 v13, v9, v4
    v_exp_f32 v12, v12
    v_fract_f32 v13, v13
    s_nop 0
    v_cos_f32 v14, v13
    v_sin_f32 v15, v13
    s_nop 0
    v_mul_f32 v14, v14, v12
    v_mul_f32 v15, v15, v12

    v_cvt_pk_bf16_f32 v32, v14, v15
    v_lshlrev_b32 v18, 16, v32
    v_and_b32 v19, 0xffff0000, v32
    v_sub_f32 v18, v14, v18
    v_sub_f32 v19, v15, v19
    v_cvt_pk_bf16_f32 v36, v18, v19

    v_mul_f32 v16, v15, v15
    v_mul_f32 v17, v14, v15
    v_fma_f32 v14, v14, v14, -v16
    v_add_f32 v15, v17, v17

    v_cvt_pk_bf16_f32 v40, v14, v15
    v_lshlrev_b32 v18, 16, v40
    v_and_b32 v19, 0xffff0000, v40
    v_sub_f32 v18, v14, v18
    v_sub_f32 v19, v15, v19
    v_cvt_pk_bf16_f32 v44, v18, v19

    v_mul_f32 v16, v15, v15
    v_mul_f32 v17, v14, v15
    v_fma_f32 v14, v14, v14, -v16
    v_add_f32 v15, v17, v17

    v_cvt_pk_bf16_f32 v48, v14, v15
    v_lshlrev_b32 v18, 16, v48
    v_and_b32 v19, 0xffff0000, v48
    v_sub_f32 v18, v14, v18
    v_sub_f32 v19, v15, v19
    v_cvt_pk_bf16_f32 v52, v18, v19

    v_mul_f32 v16, v15, v15
    v_mul_f32 v17, v14, v15
    v_fma_f32 v14, v14, v14, -v16
    v_add_f32 v15, v17, v17

    v_cvt_pk_bf16_f32 v56, v14, v15
    v_lshlrev_b32 v18, 16, v56
    v_and_b32 v19, 0xffff0000, v56
    v_sub_f32 v18, v14, v18
    v_sub_f32 v19, v15, v19
    v_cvt_pk_bf16_f32 v60, v18, v19

    v_mul_f32 v12, v8, v24
    v_mul_f32 v13, v9, v24
    v_exp_f32 v12, v12
    v_fract_f32 v13, v13
    s_nop 0
    v_cos_f32 v14, v13
    v_sin_f32 v15, v13
    s_nop 0
    v_mul_f32 v14, v14, v12
    v_mul_f32 v15, v15, v12

    v_mul_f32 v16, v10, v14
    v_fma_f32 v16, -v11, v15, v16
    v_mul_f32 v17, v10, v15
    v_fmac_f32 v17, v11, v14
    v_sub_f32 v17, 0, v17

    v_cvt_pk_bf16_f32 v64, v16, v17
    v_lshlrev_b32 v18, 16, v64
    v_and_b32 v19, 0xffff0000, v64
    v_sub_f32 v18, v16, v18
    v_sub_f32 v19, v17, v19
    v_cvt_pk_bf16_f32 v68, v18, v19

    v_mul_f32 v12, v8, v25
    v_mul_f32 v13, v9, v25
    v_exp_f32 v12, v12
    v_fract_f32 v13, v13
    s_nop 0
    v_cos_f32 v14, v13
    v_sin_f32 v15, v13
    s_nop 0
    v_mul_f32 v14, v14, v12
    v_mul_f32 v15, v15, v12

    v_mul_f32 v16, v10, v14
    v_fma_f32 v16, -v11, v15, v16
    v_mul_f32 v17, v10, v15
    v_fmac_f32 v17, v11, v14
    v_sub_f32 v17, 0, v17

    v_cvt_pk_bf16_f32 v72, v16, v17
    v_lshlrev_b32 v18, 16, v72
    v_and_b32 v19, 0xffff0000, v72
    v_sub_f32 v18, v16, v18
    v_sub_f32 v19, v17, v19
    v_cvt_pk_bf16_f32 v76, v18, v19

    v_mul_f32 v16, v15, v15
    v_mul_f32 v17, v14, v15
    v_fma_f32 v14, v14, v14, -v16
    v_add_f32 v15, v17, v17

    v_mul_f32 v16, v10, v14
    v_fma_f32 v16, -v11, v15, v16
    v_mul_f32 v17, v10, v15
    v_fmac_f32 v17, v11, v14
    v_sub_f32 v17, 0, v17

    v_cvt_pk_bf16_f32 v80, v16, v17
    v_lshlrev_b32 v18, 16, v80
    v_and_b32 v19, 0xffff0000, v80
    v_sub_f32 v18, v16, v18
    v_sub_f32 v19, v17, v19
    v_cvt_pk_bf16_f32 v84, v18, v19

    v_mul_f32 v16, v15, v15
    v_mul_f32 v17, v14, v15
    v_fma_f32 v14, v14, v14, -v16
    v_add_f32 v15, v17, v17

    v_mul_f32 v16, v10, v14
    v_fma_f32 v16, -v11, v15, v16
    v_mul_f32 v17, v10, v15
    v_fmac_f32 v17, v11, v14
    v_sub_f32 v17, 0, v17

    v_cvt_pk_bf16_f32 v88, v16, v17
    v_lshlrev_b32 v18, 16, v88
    v_and_b32 v19, 0xffff0000, v88
    v_sub_f32 v18, v16, v18
    v_sub_f32 v19, v17, v19
    v_cvt_pk_bf16_f32 v92, v18, v19

    ds_read_b128 v[8:11], v20 offset:272
    s_waitcnt lgkmcnt(0)
    v_mul_f32 v12, v8, v4
    v_mul_f32 v13, v9, v4
    v_exp_f32 v12, v12
    v_fract_f32 v13, v13
    s_nop 0
    v_cos_f32 v14, v13
    v_sin_f32 v15, v13
    s_nop 0
    v_mul_f32 v14, v14, v12
    v_mul_f32 v15, v15, v12

    v_cvt_pk_bf16_f32 v33, v14, v15
    v_lshlrev_b32 v18, 16, v33
    v_and_b32 v19, 0xffff0000, v33
    v_sub_f32 v18, v14, v18
    v_sub_f32 v19, v15, v19
    v_cvt_pk_bf16_f32 v37, v18, v19

    v_mul_f32 v16, v15, v15
    v_mul_f32 v17, v14, v15
    v_fma_f32 v14, v14, v14, -v16
    v_add_f32 v15, v17, v17

    v_cvt_pk_bf16_f32 v41, v14, v15
    v_lshlrev_b32 v18, 16, v41
    v_and_b32 v19, 0xffff0000, v41
    v_sub_f32 v18, v14, v18
    v_sub_f32 v19, v15, v19
    v_cvt_pk_bf16_f32 v45, v18, v19

    v_mul_f32 v16, v15, v15
    v_mul_f32 v17, v14, v15
    v_fma_f32 v14, v14, v14, -v16
    v_add_f32 v15, v17, v17

    v_cvt_pk_bf16_f32 v49, v14, v15
    v_lshlrev_b32 v18, 16, v49
    v_and_b32 v19, 0xffff0000, v49
    v_sub_f32 v18, v14, v18
    v_sub_f32 v19, v15, v19
    v_cvt_pk_bf16_f32 v53, v18, v19

    v_mul_f32 v16, v15, v15
    v_mul_f32 v17, v14, v15
    v_fma_f32 v14, v14, v14, -v16
    v_add_f32 v15, v17, v17

    v_cvt_pk_bf16_f32 v57, v14, v15
    v_lshlrev_b32 v18, 16, v57
    v_and_b32 v19, 0xffff0000, v57
    v_sub_f32 v18, v14, v18
    v_sub_f32 v19, v15, v19
    v_cvt_pk_bf16_f32 v61, v18, v19

    v_mul_f32 v12, v8, v24
    v_mul_f32 v13, v9, v24
    v_exp_f32 v12, v12
    v_fract_f32 v13, v13
    s_nop 0
    v_cos_f32 v14, v13
    v_sin_f32 v15, v13
    s_nop 0
    v_mul_f32 v14, v14, v12
    v_mul_f32 v15, v15, v12

    v_mul_f32 v16, v10, v14
    v_fma_f32 v16, -v11, v15, v16
    v_mul_f32 v17, v10, v15
    v_fmac_f32 v17, v11, v14
    v_sub_f32 v17, 0, v17

    v_cvt_pk_bf16_f32 v65, v16, v17
    v_lshlrev_b32 v18, 16, v65
    v_and_b32 v19, 0xffff0000, v65
    v_sub_f32 v18, v16, v18
    v_sub_f32 v19, v17, v19
    v_cvt_pk_bf16_f32 v69, v18, v19

    v_mul_f32 v12, v8, v25
    v_mul_f32 v13, v9, v25
    v_exp_f32 v12, v12
    v_fract_f32 v13, v13
    s_nop 0
    v_cos_f32 v14, v13
    v_sin_f32 v15, v13
    s_nop 0
    v_mul_f32 v14, v14, v12
    v_mul_f32 v15, v15, v12

    v_mul_f32 v16, v10, v14
    v_fma_f32 v16, -v11, v15, v16
    v_mul_f32 v17, v10, v15
    v_fmac_f32 v17, v11, v14
    v_sub_f32 v17, 0, v17

    v_cvt_pk_bf16_f32 v73, v16, v17
    v_lshlrev_b32 v18, 16, v73
    v_and_b32 v19, 0xffff0000, v73
    v_sub_f32 v18, v16, v18
    v_sub_f32 v19, v17, v19
    v_cvt_pk_bf16_f32 v77, v18, v19

    v_mul_f32 v16, v15, v15
    v_mul_f32 v17, v14, v15
    v_fma_f32 v14, v14, v14, -v16
    v_add_f32 v15, v17, v17

    v_mul_f32 v16, v10, v14
    v_fma_f32 v16, -v11, v15, v16
    v_mul_f32 v17, v10, v15
    v_fmac_f32 v17, v11, v14
    v_sub_f32 v17, 0, v17

    v_cvt_pk_bf16_f32 v81, v16, v17
    v_lshlrev_b32 v18, 16, v81
    v_and_b32 v19, 0xffff0000, v81
    v_sub_f32 v18, v16, v18
    v_sub_f32 v19, v17, v19
    v_cvt_pk_bf16_f32 v85, v18, v19

    v_mul_f32 v16, v15, v15
    v_mul_f32 v17, v14, v15
    v_fma_f32 v14, v14, v14, -v16
    v_add_f32 v15, v17, v17

    v_mul_f32 v16, v10, v14
    v_fma_f32 v16, -v11, v15, v16
    v_mul_f32 v17, v10, v15
    v_fmac_f32 v17, v11, v14
    v_sub_f32 v17, 0, v17

    v_cvt_pk_bf16_f32 v89, v16, v17
    v_lshlrev_b32 v18, 16, v89
    v_and_b32 v19, 0xffff0000, v89
    v_sub_f32 v18, v16, v18
    v_sub_f32 v19, v17, v19
    v_cvt_pk_bf16_f32 v93, v18, v19

    ds_read_b128 v[8:11], v20 offset:288
    s_waitcnt lgkmcnt(0)
    v_mul_f32 v12, v8, v4
    v_mul_f32 v13, v9, v4
    v_exp_f32 v12, v12
    v_fract_f32 v13, v13
    s_nop 0
    v_cos_f32 v14, v13
    v_sin_f32 v15, v13
    s_nop 0
    v_mul_f32 v14, v14, v12
    v_mul_f32 v15, v15, v12

    v_cvt_pk_bf16_f32 v34, v14, v15
    v_lshlrev_b32 v18, 16, v34
    v_and_b32 v19, 0xffff0000, v34
    v_sub_f32 v18, v14, v18
    v_sub_f32 v19, v15, v19
    v_cvt_pk_bf16_f32 v38, v18, v19

    v_mul_f32 v16, v15, v15
    v_mul_f32 v17, v14, v15
    v_fma_f32 v14, v14, v14, -v16
    v_add_f32 v15, v17, v17

    v_cvt_pk_bf16_f32 v42, v14, v15
    v_lshlrev_b32 v18, 16, v42
    v_and_b32 v19, 0xffff0000, v42
    v_sub_f32 v18, v14, v18
    v_sub_f32 v19, v15, v19
    v_cvt_pk_bf16_f32 v46, v18, v19

    v_mul_f32 v16, v15, v15
    v_mul_f32 v17, v14, v15
    v_fma_f32 v14, v14, v14, -v16
    v_add_f32 v15, v17, v17

    v_cvt_pk_bf16_f32 v50, v14, v15
    v_lshlrev_b32 v18, 16, v50
    v_and_b32 v19, 0xffff0000, v50
    v_sub_f32 v18, v14, v18
    v_sub_f32 v19, v15, v19
    v_cvt_pk_bf16_f32 v54, v18, v19

    v_mul_f32 v16, v15, v15
    v_mul_f32 v17, v14, v15
    v_fma_f32 v14, v14, v14, -v16
    v_add_f32 v15, v17, v17

    v_cvt_pk_bf16_f32 v58, v14, v15
    v_lshlrev_b32 v18, 16, v58
    v_and_b32 v19, 0xffff0000, v58
    v_sub_f32 v18, v14, v18
    v_sub_f32 v19, v15, v19
    v_cvt_pk_bf16_f32 v62, v18, v19

    v_mul_f32 v12, v8, v24
    v_mul_f32 v13, v9, v24
    v_exp_f32 v12, v12
    v_fract_f32 v13, v13
    s_nop 0
    v_cos_f32 v14, v13
    v_sin_f32 v15, v13
    s_nop 0
    v_mul_f32 v14, v14, v12
    v_mul_f32 v15, v15, v12

    v_mul_f32 v16, v10, v14
    v_fma_f32 v16, -v11, v15, v16
    v_mul_f32 v17, v10, v15
    v_fmac_f32 v17, v11, v14
    v_sub_f32 v17, 0, v17

    v_cvt_pk_bf16_f32 v66, v16, v17
    v_lshlrev_b32 v18, 16, v66
    v_and_b32 v19, 0xffff0000, v66
    v_sub_f32 v18, v16, v18
    v_sub_f32 v19, v17, v19
    v_cvt_pk_bf16_f32 v70, v18, v19

    v_mul_f32 v12, v8, v25
    v_mul_f32 v13, v9, v25
    v_exp_f32 v12, v12
    v_fract_f32 v13, v13
    s_nop 0
    v_cos_f32 v14, v13
    v_sin_f32 v15, v13
    s_nop 0
    v_mul_f32 v14, v14, v12
    v_mul_f32 v15, v15, v12

    v_mul_f32 v16, v10, v14
    v_fma_f32 v16, -v11, v15, v16
    v_mul_f32 v17, v10, v15
    v_fmac_f32 v17, v11, v14
    v_sub_f32 v17, 0, v17

    v_cvt_pk_bf16_f32 v74, v16, v17
    v_lshlrev_b32 v18, 16, v74
    v_and_b32 v19, 0xffff0000, v74
    v_sub_f32 v18, v16, v18
    v_sub_f32 v19, v17, v19
    v_cvt_pk_bf16_f32 v78, v18, v19

    v_mul_f32 v16, v15, v15
    v_mul_f32 v17, v14, v15
    v_fma_f32 v14, v14, v14, -v16
    v_add_f32 v15, v17, v17

    v_mul_f32 v16, v10, v14
    v_fma_f32 v16, -v11, v15, v16
    v_mul_f32 v17, v10, v15
    v_fmac_f32 v17, v11, v14
    v_sub_f32 v17, 0, v17

    v_cvt_pk_bf16_f32 v82, v16, v17
    v_lshlrev_b32 v18, 16, v82
    v_and_b32 v19, 0xffff0000, v82
    v_sub_f32 v18, v16, v18
    v_sub_f32 v19, v17, v19
    v_cvt_pk_bf16_f32 v86, v18, v19

    v_mul_f32 v16, v15, v15
    v_mul_f32 v17, v14, v15
    v_fma_f32 v14, v14, v14, -v16
    v_add_f32 v15, v17, v17

    v_mul_f32 v16, v10, v14
    v_fma_f32 v16, -v11, v15, v16
    v_mul_f32 v17, v10, v15
    v_fmac_f32 v17, v11, v14
    v_sub_f32 v17, 0, v17

    v_cvt_pk_bf16_f32 v90, v16, v17
    v_lshlrev_b32 v18, 16, v90
    v_and_b32 v19, 0xffff0000, v90
    v_sub_f32 v18, v16, v18
    v_sub_f32 v19, v17, v19
    v_cvt_pk_bf16_f32 v94, v18, v19

    ds_read_b128 v[8:11], v20 offset:304
    s_waitcnt lgkmcnt(0)
    v_mul_f32 v12, v8, v4
    v_mul_f32 v13, v9, v4
    v_exp_f32 v12, v12
    v_fract_f32 v13, v13
    s_nop 0
    v_cos_f32 v14, v13
    v_sin_f32 v15, v13
    s_nop 0
    v_mul_f32 v14, v14, v12
    v_mul_f32 v15, v15, v12

    v_cvt_pk_bf16_f32 v35, v14, v15
    v_lshlrev_b32 v18, 16, v35
    v_and_b32 v19, 0xffff0000, v35
    v_sub_f32 v18, v14, v18
    v_sub_f32 v19, v15, v19
    v_cvt_pk_bf16_f32 v39, v18, v19

    v_mul_f32 v16, v15, v15
    v_mul_f32 v17, v14, v15
    v_fma_f32 v14, v14, v14, -v16
    v_add_f32 v15, v17, v17

    v_cvt_pk_bf16_f32 v43, v14, v15
    v_lshlrev_b32 v18, 16, v43
    v_and_b32 v19, 0xffff0000, v43
    v_sub_f32 v18, v14, v18
    v_sub_f32 v19, v15, v19
    v_cvt_pk_bf16_f32 v47, v18, v19

    v_mul_f32 v16, v15, v15
    v_mul_f32 v17, v14, v15
    v_fma_f32 v14, v14, v14, -v16
    v_add_f32 v15, v17, v17

    v_cvt_pk_bf16_f32 v51, v14, v15
    v_lshlrev_b32 v18, 16, v51
    v_and_b32 v19, 0xffff0000, v51
    v_sub_f32 v18, v14, v18
    v_sub_f32 v19, v15, v19
    v_cvt_pk_bf16_f32 v55, v18, v19

    v_mul_f32 v16, v15, v15
    v_mul_f32 v17, v14, v15
    v_fma_f32 v14, v14, v14, -v16
    v_add_f32 v15, v17, v17

    v_cvt_pk_bf16_f32 v59, v14, v15
    v_lshlrev_b32 v18, 16, v59
    v_and_b32 v19, 0xffff0000, v59
    v_sub_f32 v18, v14, v18
    v_sub_f32 v19, v15, v19
    v_cvt_pk_bf16_f32 v63, v18, v19

    v_mul_f32 v12, v8, v24
    v_mul_f32 v13, v9, v24
    v_exp_f32 v12, v12
    v_fract_f32 v13, v13
    s_nop 0
    v_cos_f32 v14, v13
    v_sin_f32 v15, v13
    s_nop 0
    v_mul_f32 v14, v14, v12
    v_mul_f32 v15, v15, v12

    v_mul_f32 v16, v10, v14
    v_fma_f32 v16, -v11, v15, v16
    v_mul_f32 v17, v10, v15
    v_fmac_f32 v17, v11, v14
    v_sub_f32 v17, 0, v17

    v_cvt_pk_bf16_f32 v67, v16, v17
    v_lshlrev_b32 v18, 16, v67
    v_and_b32 v19, 0xffff0000, v67
    v_sub_f32 v18, v16, v18
    v_sub_f32 v19, v17, v19
    v_cvt_pk_bf16_f32 v71, v18, v19

    v_mul_f32 v12, v8, v25
    v_mul_f32 v13, v9, v25
    v_exp_f32 v12, v12
    v_fract_f32 v13, v13
    s_nop 0
    v_cos_f32 v14, v13
    v_sin_f32 v15, v13
    s_nop 0
    v_mul_f32 v14, v14, v12
    v_mul_f32 v15, v15, v12

    v_mul_f32 v16, v10, v14
    v_fma_f32 v16, -v11, v15, v16
    v_mul_f32 v17, v10, v15
    v_fmac_f32 v17, v11, v14
    v_sub_f32 v17, 0, v17

    v_cvt_pk_bf16_f32 v75, v16, v17
    v_lshlrev_b32 v18, 16, v75
    v_and_b32 v19, 0xffff0000, v75
    v_sub_f32 v18, v16, v18
    v_sub_f32 v19, v17, v19
    v_cvt_pk_bf16_f32 v79, v18, v19

    v_mul_f32 v16, v15, v15
    v_mul_f32 v17, v14, v15
    v_fma_f32 v14, v14, v14, -v16
    v_add_f32 v15, v17, v17

    v_mul_f32 v16, v10, v14
    v_fma_f32 v16, -v11, v15, v16
    v_mul_f32 v17, v10, v15
    v_fmac_f32 v17, v11, v14
    v_sub_f32 v17, 0, v17

    v_cvt_pk_bf16_f32 v83, v16, v17
    v_lshlrev_b32 v18, 16, v83
    v_and_b32 v19, 0xffff0000, v83
    v_sub_f32 v18, v16, v18
    v_sub_f32 v19, v17, v19
    v_cvt_pk_bf16_f32 v87, v18, v19

    v_mul_f32 v16, v15, v15
    v_mul_f32 v17, v14, v15
    v_fma_f32 v14, v14, v14, -v16
    v_add_f32 v15, v17, v17

    v_mul_f32 v16, v10, v14
    v_fma_f32 v16, -v11, v15, v16
    v_mul_f32 v17, v10, v15
    v_fmac_f32 v17, v11, v14
    v_sub_f32 v17, 0, v17

    v_cvt_pk_bf16_f32 v91, v16, v17
    v_lshlrev_b32 v18, 16, v91
    v_and_b32 v19, 0xffff0000, v91
    v_sub_f32 v18, v16, v18
    v_sub_f32 v19, v17, v19
    v_cvt_pk_bf16_f32 v95, v18, v19

    s_nop 1
    v_mfma_f32_16x16x32_bf16 v[96:99], v[64:67], v[32:35], v[96:99]
    v_mfma_f32_16x16x32_bf16 v[96:99], v[64:67], v[36:39], v[96:99]
    v_mfma_f32_16x16x32_bf16 v[96:99], v[68:71], v[32:35], v[96:99]
    v_mfma_f32_16x16x32_bf16 v[100:103], v[72:75], v[40:43], v[100:103]
    v_mfma_f32_16x16x32_bf16 v[100:103], v[72:75], v[44:47], v[100:103]
    v_mfma_f32_16x16x32_bf16 v[100:103], v[76:79], v[40:43], v[100:103]
    v_mfma_f32_16x16x32_bf16 v[104:107], v[80:83], v[48:51], v[104:107]
    v_mfma_f32_16x16x32_bf16 v[104:107], v[80:83], v[52:55], v[104:107]
    v_mfma_f32_16x16x32_bf16 v[104:107], v[84:87], v[48:51], v[104:107]
    v_mfma_f32_16x16x32_bf16 v[108:111], v[88:91], v[56:59], v[108:111]
    v_mfma_f32_16x16x32_bf16 v[108:111], v[88:91], v[60:63], v[108:111]
    v_mfma_f32_16x16x32_bf16 v[108:111], v[92:95], v[56:59], v[108:111]
    s_nop 15
    v_lshlrev_b32 v21, 12, v2
    v_lshl_add_u32 v21, v5, 8, v21
    v_lshl_add_u32 v21, v3, 2, v21
    v_add_u32 v21, 50816, v21
    ds_write_b32 v21, v96 offset:0
    ds_write_b32 v21, v97 offset:64
    ds_write_b32 v21, v98 offset:128
    ds_write_b32 v21, v99 offset:192
    ds_write_b32 v21, v100 offset:1024
    ds_write_b32 v21, v101 offset:1088
    ds_write_b32 v21, v102 offset:1152
    ds_write_b32 v21, v103 offset:1216
    ds_write_b32 v21, v104 offset:2048
    ds_write_b32 v21, v105 offset:2112
    ds_write_b32 v21, v106 offset:2176
    ds_write_b32 v21, v107 offset:2240
    ds_write_b32 v21, v108 offset:3072
    ds_write_b32 v21, v109 offset:3136
    ds_write_b32 v21, v110 offset:3200
    ds_write_b32 v21, v111 offset:3264
    s_waitcnt lgkmcnt(0)
    s_barrier
    v_add_u32 v8, 0, v0
    v_mov_b32 v9, 0
    v_cmp_le_u32 vcc, 256, v8
    v_addc_co_u32 v9, vcc, 0, v9, vcc
    v_cmp_le_u32 vcc, 512, v8
    v_addc_co_u32 v9, vcc, 0, v9, vcc
    v_cmp_le_u32 vcc, 1024, v8
    v_addc_co_u32 v9, vcc, 0, v9, vcc
    v_lshrrev_b32 v10, v9, v8
    v_lshlrev_b32 v11, v9, v10
    v_sub_u32 v11, v8, v11
    v_lshlrev_b32 v11, 1, v11
    v_and_b32 v12, 1, v10
    v_add_u32 v11, v11, v12
    v_lshlrev_b32 v12, v9, 1
    v_cmp_gt_u32 vcc, v11, v12
    v_addc_co_u32 v10, vcc, 0, v10, vcc
    v_cmp_lt_u32 vcc, 0, v9
    v_mov_b32 v12, 128
    v_cndmask_b32 v12, 0, v12, vcc
    v_sub_u32 v10, v10, v12
    v_lshl_add_u32 v10, v9, 8, v10
    v_lshlrev_b32 v10, 2, v10
    v_add_u32 v10, 50816, v10
    ds_read_b32 v11, v10
    ds_read_b32 v12, v10 offset:4096
    ds_read_b32 v15, v10 offset:8192
    ds_read_b32 v16, v10 offset:12288
    v_sub_u32 v13, 2304, v8
    v_lshlrev_b32 v13, 1, v13
    s_waitcnt lgkmcnt(0)
    v_add_f32 v11, v11, v12
    v_add_f32 v15, v15, v16
    v_add_f32 v11, v11, v15
    v_cvt_pk_bf16_f32 v12, v11, v11
    v_lshlrev_b32 v14, 16, v12
    v_sub_f32 v14, v11, v14
    v_cvt_pk_bf16_f32 v14, v14, v14
    ds_write_b16 v13, v12 offset:20480
    ds_write_b16 v13, v14 offset:25600

    v_add_u32 v8, 512, v0
    v_mov_b32 v9, 0
    v_cmp_le_u32 vcc, 256, v8
    v_addc_co_u32 v9, vcc, 0, v9, vcc
    v_cmp_le_u32 vcc, 512, v8
    v_addc_co_u32 v9, vcc, 0, v9, vcc
    v_cmp_le_u32 vcc, 1024, v8
    v_addc_co_u32 v9, vcc, 0, v9, vcc
    v_lshrrev_b32 v10, v9, v8
    v_lshlrev_b32 v11, v9, v10
    v_sub_u32 v11, v8, v11
    v_lshlrev_b32 v11, 1, v11
    v_and_b32 v12, 1, v10
    v_add_u32 v11, v11, v12
    v_lshlrev_b32 v12, v9, 1
    v_cmp_gt_u32 vcc, v11, v12
    v_addc_co_u32 v10, vcc, 0, v10, vcc
    v_cmp_lt_u32 vcc, 0, v9
    v_mov_b32 v12, 128
    v_cndmask_b32 v12, 0, v12, vcc
    v_sub_u32 v10, v10, v12
    v_lshl_add_u32 v10, v9, 8, v10
    v_lshlrev_b32 v10, 2, v10
    v_add_u32 v10, 50816, v10
    ds_read_b32 v11, v10
    ds_read_b32 v12, v10 offset:4096
    ds_read_b32 v15, v10 offset:8192
    ds_read_b32 v16, v10 offset:12288
    v_sub_u32 v13, 2304, v8
    v_lshlrev_b32 v13, 1, v13
    s_waitcnt lgkmcnt(0)
    v_add_f32 v11, v11, v12
    v_add_f32 v15, v15, v16
    v_add_f32 v11, v11, v15
    v_cvt_pk_bf16_f32 v12, v11, v11
    v_lshlrev_b32 v14, 16, v12
    v_sub_f32 v14, v11, v14
    v_cvt_pk_bf16_f32 v14, v14, v14
    ds_write_b16 v13, v12 offset:20480
    ds_write_b16 v13, v14 offset:25600

    v_add_u32 v8, 1024, v0
    v_mov_b32 v9, 0
    v_cmp_le_u32 vcc, 256, v8
    v_addc_co_u32 v9, vcc, 0, v9, vcc
    v_cmp_le_u32 vcc, 512, v8
    v_addc_co_u32 v9, vcc, 0, v9, vcc
    v_cmp_le_u32 vcc, 1024, v8
    v_addc_co_u32 v9, vcc, 0, v9, vcc
    v_lshrrev_b32 v10, v9, v8
    v_lshlrev_b32 v11, v9, v10
    v_sub_u32 v11, v8, v11
    v_lshlrev_b32 v11, 1, v11
    v_and_b32 v12, 1, v10
    v_add_u32 v11, v11, v12
    v_lshlrev_b32 v12, v9, 1
    v_cmp_gt_u32 vcc, v11, v12
    v_addc_co_u32 v10, vcc, 0, v10, vcc
    v_cmp_lt_u32 vcc, 0, v9
    v_mov_b32 v12, 128
    v_cndmask_b32 v12, 0, v12, vcc
    v_sub_u32 v10, v10, v12
    v_lshl_add_u32 v10, v9, 8, v10
    v_lshlrev_b32 v10, 2, v10
    v_add_u32 v10, 50816, v10
    ds_read_b32 v11, v10
    ds_read_b32 v12, v10 offset:4096
    ds_read_b32 v15, v10 offset:8192
    ds_read_b32 v16, v10 offset:12288
    v_sub_u32 v13, 2304, v8
    v_lshlrev_b32 v13, 1, v13
    s_waitcnt lgkmcnt(0)
    v_add_f32 v11, v11, v12
    v_add_f32 v15, v15, v16
    v_add_f32 v11, v11, v15
    v_cvt_pk_bf16_f32 v12, v11, v11
    v_lshlrev_b32 v14, 16, v12
    v_sub_f32 v14, v11, v14
    v_cvt_pk_bf16_f32 v14, v14, v14
    ds_write_b16 v13, v12 offset:20480
    ds_write_b16 v13, v14 offset:25600

    v_add_u32 v8, 1536, v0
    v_mov_b32 v9, 0
    v_cmp_le_u32 vcc, 256, v8
    v_addc_co_u32 v9, vcc, 0, v9, vcc
    v_cmp_le_u32 vcc, 512, v8
    v_addc_co_u32 v9, vcc, 0, v9, vcc
    v_cmp_le_u32 vcc, 1024, v8
    v_addc_co_u32 v9, vcc, 0, v9, vcc
    v_lshrrev_b32 v10, v9, v8
    v_lshlrev_b32 v11, v9, v10
    v_sub_u32 v11, v8, v11
    v_lshlrev_b32 v11, 1, v11
    v_and_b32 v12, 1, v10
    v_add_u32 v11, v11, v12
    v_lshlrev_b32 v12, v9, 1
    v_cmp_gt_u32 vcc, v11, v12
    v_addc_co_u32 v10, vcc, 0, v10, vcc
    v_cmp_lt_u32 vcc, 0, v9
    v_mov_b32 v12, 128
    v_cndmask_b32 v12, 0, v12, vcc
    v_sub_u32 v10, v10, v12
    v_lshl_add_u32 v10, v9, 8, v10
    v_lshlrev_b32 v10, 2, v10
    v_add_u32 v10, 50816, v10
    ds_read_b32 v11, v10
    ds_read_b32 v12, v10 offset:4096
    ds_read_b32 v15, v10 offset:8192
    ds_read_b32 v16, v10 offset:12288
    v_sub_u32 v13, 2304, v8
    v_lshlrev_b32 v13, 1, v13
    s_waitcnt lgkmcnt(0)
    v_add_f32 v11, v11, v12
    v_add_f32 v15, v15, v16
    v_add_f32 v11, v11, v15
    v_cvt_pk_bf16_f32 v12, v11, v11
    v_lshlrev_b32 v14, 16, v12
    v_sub_f32 v14, v11, v14
    v_cvt_pk_bf16_f32 v14, v14, v14
    ds_write_b16 v13, v12 offset:20480
    ds_write_b16 v13, v14 offset:25600

    v_add_u32 v8, 0, v0
    v_mov_b32 v9, 0
    v_cmp_le_u32 vcc, 256, v8
    v_addc_co_u32 v9, vcc, 0, v9, vcc
    v_cmp_le_u32 vcc, 512, v8
    v_addc_co_u32 v9, vcc, 0, v9, vcc
    v_cmp_le_u32 vcc, 1024, v8
    v_addc_co_u32 v9, vcc, 0, v9, vcc
    v_lshrrev_b32 v10, v9, v8
    v_lshlrev_b32 v11, v9, v10
    v_sub_u32 v11, v8, v11
    v_lshlrev_b32 v11, 1, v11
    v_and_b32 v12, 1, v10
    v_add_u32 v11, v11, v12
    v_lshlrev_b32 v12, v9, 1
    v_cmp_gt_u32 vcc, v11, v12
    v_addc_co_u32 v10, vcc, 0, v10, vcc
    v_cmp_lt_u32 vcc, 0, v9
    v_mov_b32 v12, 128
    v_cndmask_b32 v12, 0, v12, vcc
    v_sub_u32 v10, v10, v12
    v_lshl_add_u32 v10, v9, 8, v10
    v_lshlrev_b32 v10, 2, v10
    v_add_u32 v10, 67200, v10
    ds_read_b32 v11, v10
    ds_read_b32 v12, v10 offset:4096
    ds_read_b32 v15, v10 offset:8192
    ds_read_b32 v16, v10 offset:12288
    v_sub_u32 v13, 2304, v8
    v_lshlrev_b32 v13, 1, v13
    s_waitcnt lgkmcnt(0)
    v_add_f32 v11, v11, v12
    v_add_f32 v15, v15, v16
    v_add_f32 v11, v11, v15
    v_cvt_pk_bf16_f32 v12, v11, v11
    v_lshlrev_b32 v14, 16, v12
    v_sub_f32 v14, v11, v14
    v_cvt_pk_bf16_f32 v14, v14, v14
    ds_write_b16 v13, v12 offset:30720
    ds_write_b16 v13, v14 offset:35840

    v_add_u32 v8, 512, v0
    v_mov_b32 v9, 0
    v_cmp_le_u32 vcc, 256, v8
    v_addc_co_u32 v9, vcc, 0, v9, vcc
    v_cmp_le_u32 vcc, 512, v8
    v_addc_co_u32 v9, vcc, 0, v9, vcc
    v_cmp_le_u32 vcc, 1024, v8
    v_addc_co_u32 v9, vcc, 0, v9, vcc
    v_lshrrev_b32 v10, v9, v8
    v_lshlrev_b32 v11, v9, v10
    v_sub_u32 v11, v8, v11
    v_lshlrev_b32 v11, 1, v11
    v_and_b32 v12, 1, v10
    v_add_u32 v11, v11, v12
    v_lshlrev_b32 v12, v9, 1
    v_cmp_gt_u32 vcc, v11, v12
    v_addc_co_u32 v10, vcc, 0, v10, vcc
    v_cmp_lt_u32 vcc, 0, v9
    v_mov_b32 v12, 128
    v_cndmask_b32 v12, 0, v12, vcc
    v_sub_u32 v10, v10, v12
    v_lshl_add_u32 v10, v9, 8, v10
    v_lshlrev_b32 v10, 2, v10
    v_add_u32 v10, 67200, v10
    ds_read_b32 v11, v10
    ds_read_b32 v12, v10 offset:4096
    ds_read_b32 v15, v10 offset:8192
    ds_read_b32 v16, v10 offset:12288
    v_sub_u32 v13, 2304, v8
    v_lshlrev_b32 v13, 1, v13
    s_waitcnt lgkmcnt(0)
    v_add_f32 v11, v11, v12
    v_add_f32 v15, v15, v16
    v_add_f32 v11, v11, v15
    v_cvt_pk_bf16_f32 v12, v11, v11
    v_lshlrev_b32 v14, 16, v12
    v_sub_f32 v14, v11, v14
    v_cvt_pk_bf16_f32 v14, v14, v14
    ds_write_b16 v13, v12 offset:30720
    ds_write_b16 v13, v14 offset:35840

    v_add_u32 v8, 1024, v0
    v_mov_b32 v9, 0
    v_cmp_le_u32 vcc, 256, v8
    v_addc_co_u32 v9, vcc, 0, v9, vcc
    v_cmp_le_u32 vcc, 512, v8
    v_addc_co_u32 v9, vcc, 0, v9, vcc
    v_cmp_le_u32 vcc, 1024, v8
    v_addc_co_u32 v9, vcc, 0, v9, vcc
    v_lshrrev_b32 v10, v9, v8
    v_lshlrev_b32 v11, v9, v10
    v_sub_u32 v11, v8, v11
    v_lshlrev_b32 v11, 1, v11
    v_and_b32 v12, 1, v10
    v_add_u32 v11, v11, v12
    v_lshlrev_b32 v12, v9, 1
    v_cmp_gt_u32 vcc, v11, v12
    v_addc_co_u32 v10, vcc, 0, v10, vcc
    v_cmp_lt_u32 vcc, 0, v9
    v_mov_b32 v12, 128
    v_cndmask_b32 v12, 0, v12, vcc
    v_sub_u32 v10, v10, v12
    v_lshl_add_u32 v10, v9, 8, v10
    v_lshlrev_b32 v10, 2, v10
    v_add_u32 v10, 67200, v10
    ds_read_b32 v11, v10
    ds_read_b32 v12, v10 offset:4096
    ds_read_b32 v15, v10 offset:8192
    ds_read_b32 v16, v10 offset:12288
    v_sub_u32 v13, 2304, v8
    v_lshlrev_b32 v13, 1, v13
    s_waitcnt lgkmcnt(0)
    v_add_f32 v11, v11, v12
    v_add_f32 v15, v15, v16
    v_add_f32 v11, v11, v15
    v_cvt_pk_bf16_f32 v12, v11, v11
    v_lshlrev_b32 v14, 16, v12
    v_sub_f32 v14, v11, v14
    v_cvt_pk_bf16_f32 v14, v14, v14
    ds_write_b16 v13, v12 offset:30720
    ds_write_b16 v13, v14 offset:35840

    v_add_u32 v8, 1536, v0
    v_mov_b32 v9, 0
    v_cmp_le_u32 vcc, 256, v8
    v_addc_co_u32 v9, vcc, 0, v9, vcc
    v_cmp_le_u32 vcc, 512, v8
    v_addc_co_u32 v9, vcc, 0, v9, vcc
    v_cmp_le_u32 vcc, 1024, v8
    v_addc_co_u32 v9, vcc, 0, v9, vcc
    v_lshrrev_b32 v10, v9, v8
    v_lshlrev_b32 v11, v9, v10
    v_sub_u32 v11, v8, v11
    v_lshlrev_b32 v11, 1, v11
    v_and_b32 v12, 1, v10
    v_add_u32 v11, v11, v12
    v_lshlrev_b32 v12, v9, 1
    v_cmp_gt_u32 vcc, v11, v12
    v_addc_co_u32 v10, vcc, 0, v10, vcc
    v_cmp_lt_u32 vcc, 0, v9
    v_mov_b32 v12, 128
    v_cndmask_b32 v12, 0, v12, vcc
    v_sub_u32 v10, v10, v12
    v_lshl_add_u32 v10, v9, 8, v10
    v_lshlrev_b32 v10, 2, v10
    v_add_u32 v10, 67200, v10
    ds_read_b32 v11, v10
    ds_read_b32 v12, v10 offset:4096
    ds_read_b32 v15, v10 offset:8192
    ds_read_b32 v16, v10 offset:12288
    v_sub_u32 v13, 2304, v8
    v_lshlrev_b32 v13, 1, v13
    s_waitcnt lgkmcnt(0)
    v_add_f32 v11, v11, v12
    v_add_f32 v15, v15, v16
    v_add_f32 v11, v11, v15
    v_cvt_pk_bf16_f32 v12, v11, v11
    v_lshlrev_b32 v14, 16, v12
    v_sub_f32 v14, v11, v14
    v_cvt_pk_bf16_f32 v14, v14, v14
    ds_write_b16 v13, v12 offset:30720
    ds_write_b16 v13, v14 offset:35840

    s_waitcnt lgkmcnt(0)
    s_barrier
    v_add_u32 v8, 0, v0
    v_cmp_gt_u32 vcc, 1152, v8
    s_and_saveexec_b64 s[40:41], vcc
    v_lshlrev_b32 v9, 2, v8
    ds_read_b32 v12, v9 offset:40960
    ds_read_b32 v13, v9 offset:40964
    ds_read_b32 v14, v9 offset:40968
    ds_read_b32 v15, v9 offset:40972
    ds_read_b32 v16, v9 offset:40976
    v_lshrrev_b32 v10, 7, v8
    v_mul_u32_u24 v10, 576, v10
    v_and_b32 v11, 127, v8
    v_lshl_add_u32 v10, v11, 2, v10
    s_waitcnt lgkmcnt(0)

    v_add_u32 v10, 50816, v10
    ds_write_b32 v10, v12 offset:0
    v_alignbit_b32 v17, v13, v12, 16
    ds_write_b32 v10, v17 offset:5200
    ds_write_b32 v10, v13 offset:10400
    v_alignbit_b32 v17, v14, v13, 16
    ds_write_b32 v10, v17 offset:15600
    ds_write_b32 v10, v14 offset:20800
    v_alignbit_b32 v17, v15, v14, 16
    ds_write_b32 v10, v17 offset:26000
    ds_write_b32 v10, v15 offset:31200
    v_alignbit_b32 v17, v16, v15, 16
    ds_write_b32 v10, v17 offset:36400
    s_mov_b64 exec, s[40:41]
    v_add_u32 v8, 512, v0
    v_cmp_gt_u32 vcc, 1152, v8
    s_and_saveexec_b64 s[40:41], vcc
    v_lshlrev_b32 v9, 2, v8
    ds_read_b32 v12, v9 offset:40960
    ds_read_b32 v13, v9 offset:40964
    ds_read_b32 v14, v9 offset:40968
    ds_read_b32 v15, v9 offset:40972
    ds_read_b32 v16, v9 offset:40976
    v_lshrrev_b32 v10, 7, v8
    v_mul_u32_u24 v10, 576, v10
    v_and_b32 v11, 127, v8
    v_lshl_add_u32 v10, v11, 2, v10
    s_waitcnt lgkmcnt(0)

    v_add_u32 v10, 50816, v10
    ds_write_b32 v10, v12 offset:0
    v_alignbit_b32 v17, v13, v12, 16
    ds_write_b32 v10, v17 offset:5200
    ds_write_b32 v10, v13 offset:10400
    v_alignbit_b32 v17, v14, v13, 16
    ds_write_b32 v10, v17 offset:15600
    ds_write_b32 v10, v14 offset:20800
    v_alignbit_b32 v17, v15, v14, 16
    ds_write_b32 v10, v17 offset:26000
    ds_write_b32 v10, v15 offset:31200
    v_alignbit_b32 v17, v16, v15, 16
    ds_write_b32 v10, v17 offset:36400
    s_mov_b64 exec, s[40:41]
    v_add_u32 v8, 1024, v0
    v_cmp_gt_u32 vcc, 1152, v8
    s_and_saveexec_b64 s[40:41], vcc
    v_lshlrev_b32 v9, 2, v8
    ds_read_b32 v12, v9 offset:40960
    ds_read_b32 v13, v9 offset:40964
    ds_read_b32 v14, v9 offset:40968
    ds_read_b32 v15, v9 offset:40972
    ds_read_b32 v16, v9 offset:40976
    v_lshrrev_b32 v10, 7, v8
    v_mul_u32_u24 v10, 576, v10
    v_and_b32 v11, 127, v8
    v_lshl_add_u32 v10, v11, 2, v10
    s_waitcnt lgkmcnt(0)

    v_add_u32 v10, 50816, v10
    ds_write_b32 v10, v12 offset:0
    v_alignbit_b32 v17, v13, v12, 16
    ds_write_b32 v10, v17 offset:5200
    ds_write_b32 v10, v13 offset:10400
    v_alignbit_b32 v17, v14, v13, 16
    ds_write_b32 v10, v17 offset:15600
    ds_write_b32 v10, v14 offset:20800
    v_alignbit_b32 v17, v15, v14, 16
    ds_write_b32 v10, v17 offset:26000
    ds_write_b32 v10, v15 offset:31200
    v_alignbit_b32 v17, v16, v15, 16
    ds_write_b32 v10, v17 offset:36400
    s_mov_b64 exec, s[40:41]
    v_add_u32 v8, 0, v0
    v_cmp_gt_u32 vcc, 1152, v8
    s_and_saveexec_b64 s[40:41], vcc
    v_lshlrev_b32 v9, 2, v8
    ds_read_b32 v12, v9 offset:45632
    ds_read_b32 v13, v9 offset:45636
    ds_read_b32 v14, v9 offset:45640
    ds_read_b32 v15, v9 offset:45644
    ds_read_b32 v16, v9 offset:45648
    v_lshrrev_b32 v10, 7, v8
    v_mul_u32_u24 v10, 576, v10
    v_and_b32 v11, 127, v8
    v_lshl_add_u32 v10, v11, 2, v10
    s_waitcnt lgkmcnt(0)

    v_add_u32 v10, 92416, v10
    ds_write_b32 v10, v12 offset:0
    v_alignbit_b32 v17, v13, v12, 16
    ds_write_b32 v10, v17 offset:5200
    ds_write_b32 v10, v13 offset:10400
    v_alignbit_b32 v17, v14, v13, 16
    ds_write_b32 v10, v17 offset:15600
    ds_write_b32 v10, v14 offset:20800
    v_alignbit_b32 v17, v15, v14, 16
    ds_write_b32 v10, v17 offset:26000
    ds_write_b32 v10, v15 offset:31200
    v_alignbit_b32 v17, v16, v15, 16
    ds_write_b32 v10, v17 offset:36400
    s_mov_b64 exec, s[40:41]
    v_add_u32 v8, 512, v0
    v_cmp_gt_u32 vcc, 1152, v8
    s_and_saveexec_b64 s[40:41], vcc
    v_lshlrev_b32 v9, 2, v8
    ds_read_b32 v12, v9 offset:45632
    ds_read_b32 v13, v9 offset:45636
    ds_read_b32 v14, v9 offset:45640
    ds_read_b32 v15, v9 offset:45644
    ds_read_b32 v16, v9 offset:45648
    v_lshrrev_b32 v10, 7, v8
    v_mul_u32_u24 v10, 576, v10
    v_and_b32 v11, 127, v8
    v_lshl_add_u32 v10, v11, 2, v10
    s_waitcnt lgkmcnt(0)

    v_add_u32 v10, 92416, v10
    ds_write_b32 v10, v12 offset:0
    v_alignbit_b32 v17, v13, v12, 16
    ds_write_b32 v10, v17 offset:5200
    ds_write_b32 v10, v13 offset:10400
    v_alignbit_b32 v17, v14, v13, 16
    ds_write_b32 v10, v17 offset:15600
    ds_write_b32 v10, v14 offset:20800
    v_alignbit_b32 v17, v15, v14, 16
    ds_write_b32 v10, v17 offset:26000
    ds_write_b32 v10, v15 offset:31200
    v_alignbit_b32 v17, v16, v15, 16
    ds_write_b32 v10, v17 offset:36400
    s_mov_b64 exec, s[40:41]
    v_add_u32 v8, 1024, v0
    v_cmp_gt_u32 vcc, 1152, v8
    s_and_saveexec_b64 s[40:41], vcc
    v_lshlrev_b32 v9, 2, v8
    ds_read_b32 v12, v9 offset:45632
    ds_read_b32 v13, v9 offset:45636
    ds_read_b32 v14, v9 offset:45640
    ds_read_b32 v15, v9 offset:45644
    ds_read_b32 v16, v9 offset:45648
    v_lshrrev_b32 v10, 7, v8
    v_mul_u32_u24 v10, 576, v10
    v_and_b32 v11, 127, v8
    v_lshl_add_u32 v10, v11, 2, v10
    s_waitcnt lgkmcnt(0)

    v_add_u32 v10, 92416, v10
    ds_write_b32 v10, v12 offset:0
    v_alignbit_b32 v17, v13, v12, 16
    ds_write_b32 v10, v17 offset:5200
    ds_write_b32 v10, v13 offset:10400
    v_alignbit_b32 v17, v14, v13, 16
    ds_write_b32 v10, v17 offset:15600
    ds_write_b32 v10, v14 offset:20800
    v_alignbit_b32 v17, v15, v14, 16
    ds_write_b32 v10, v17 offset:26000
    ds_write_b32 v10, v15 offset:31200
    v_alignbit_b32 v17, v16, v15, 16
    ds_write_b32 v10, v17 offset:36400
    s_mov_b64 exec, s[40:41]
    s_waitcnt lgkmcnt(0)
    s_barrier
    v_and_b32 v3, 31, v1
    v_lshrrev_b32 v4, 5, v1
    v_lshrrev_b32 v6, 2, v2
    v_and_b32 v7, 3, v2
    v_mul_u32_u24 v8, 10240, v6
    v_lshlrev_b32 v9, 4, v3
    v_sub_u32 v8, v8, v9
    v_lshl_add_u32 v8, v4, 4, v8
    v_lshl_add_u32 v8, v7, 5, v8
    v_add_u32 v8, 20992, v8
    v_lshrrev_b32 v10, 3, v3
    v_and_b32 v11, 7, v3
    v_mul_u32_u24 v12, 5200, v11
    v_mul_u32_u24 v13, 41600, v6
    v_add_u32 v12, v12, v13
    v_mul_u32_u24 v13, 576, v10
    v_add_u32 v12, v12, v13
    v_lshl_add_u32 v12, v4, 4, v12
    v_lshl_add_u32 v12, v7, 5, v12
    v_add_u32 v12, 50816, v12
    v_mov_b32 v13, 50304

    v_mov_b32 v96, 0
    v_mov_b32 v97, 0
    v_mov_b32 v98, 0
    v_mov_b32 v99, 0
    v_mov_b32 v100, 0
    v_mov_b32 v101, 0
    v_mov_b32 v102, 0
    v_mov_b32 v103, 0
    v_mov_b32 v104, 0
    v_mov_b32 v105, 0
    v_mov_b32 v106, 0
    v_mov_b32 v107, 0
    v_mov_b32 v108, 0
    v_mov_b32 v109, 0
    v_mov_b32 v110, 0
    v_mov_b32 v111, 0
    v_mov_b32 v112, 0
    v_mov_b32 v113, 0
    v_mov_b32 v114, 0
    v_mov_b32 v115, 0
    v_mov_b32 v116, 0
    v_mov_b32 v117, 0
    v_mov_b32 v118, 0
    v_mov_b32 v119, 0
    v_mov_b32 v120, 0
    v_mov_b32 v121, 0
    v_mov_b32 v122, 0
    v_mov_b32 v123, 0
    v_mov_b32 v124, 0
    v_mov_b32 v125, 0
    v_mov_b32 v126, 0
    v_mov_b32 v127, 0
    v_add_u32 v14, 576, v12
    v_add_u32 v15, 2880, v12
    ds_read_b128 v[32:35], v8 offset:4096
    ds_read_b128 v[36:39], v8 offset:9216
    ds_read_b128 v[40:43], v14 offset:0
    ds_read_b128 v[44:47], v15 offset:0
    ds_read_b128 v[48:51], v8 offset:4224
    ds_read_b128 v[52:55], v8 offset:9344
    ds_read_b128 v[56:59], v14 offset:128
    ds_read_b128 v[60:63], v15 offset:128
    s_waitcnt lgkmcnt(4)
    v_mfma_f32_32x32x16_bf16 v[96:111], v[32:35], v[40:43], v[96:111]
    v_mfma_f32_32x32x16_bf16 v[96:111], v[36:39], v[40:43], v[96:111]
    v_mfma_f32_32x32x16_bf16 v[112:127], v[32:35], v[44:47], v[112:127]
    v_mfma_f32_32x32x16_bf16 v[112:127], v[36:39], v[44:47], v[112:127]
    ds_read_b128 v[32:35], v8 offset:4352
    ds_read_b128 v[36:39], v8 offset:9472
    ds_read_b128 v[40:43], v14 offset:256
    ds_read_b128 v[44:47], v15 offset:256
    s_waitcnt lgkmcnt(4)
    v_mfma_f32_32x32x16_bf16 v[96:111], v[48:51], v[56:59], v[96:111]
    v_mfma_f32_32x32x16_bf16 v[96:111], v[52:55], v[56:59], v[96:111]
    v_mfma_f32_32x32x16_bf16 v[112:127], v[48:51], v[60:63], v[112:127]
    v_mfma_f32_32x32x16_bf16 v[112:127], v[52:55], v[60:63], v[112:127]
    ds_read_b128 v[48:51], v8 offset:4480
    ds_read_b128 v[52:55], v8 offset:9600
    ds_read_b128 v[56:59], v14 offset:384
    ds_read_b128 v[60:63], v15 offset:384
    s_waitcnt lgkmcnt(4)
    v_mfma_f32_32x32x16_bf16 v[96:111], v[32:35], v[40:43], v[96:111]
    v_mfma_f32_32x32x16_bf16 v[96:111], v[36:39], v[40:43], v[96:111]
    v_mfma_f32_32x32x16_bf16 v[112:127], v[32:35], v[44:47], v[112:127]
    v_mfma_f32_32x32x16_bf16 v[112:127], v[36:39], v[44:47], v[112:127]
    v_add_u32 v16, 0, v12
    v_add_u32 v17, 2304, v12
    ds_read_b128 v[32:35], v8 offset:3584
    ds_read_b128 v[36:39], v8 offset:8704
    ds_read_b128 v[40:43], v16 offset:0
    ds_read_b128 v[44:47], v17 offset:0
    s_waitcnt lgkmcnt(4)
    v_mfma_f32_32x32x16_bf16 v[96:111], v[48:51], v[56:59], v[96:111]
    v_mfma_f32_32x32x16_bf16 v[96:111], v[52:55], v[56:59], v[96:111]
    v_mfma_f32_32x32x16_bf16 v[112:127], v[48:51], v[60:63], v[112:127]
    v_mfma_f32_32x32x16_bf16 v[112:127], v[52:55], v[60:63], v[112:127]
    ds_read_b128 v[48:51], v8 offset:3712
    ds_read_b128 v[52:55], v8 offset:8832
    ds_read_b128 v[56:59], v16 offset:128
    ds_read_b128 v[60:63], v17 offset:128
    s_waitcnt lgkmcnt(4)
    v_mfma_f32_32x32x16_bf16 v[96:111], v[32:35], v[40:43], v[96:111]
    v_mfma_f32_32x32x16_bf16 v[96:111], v[36:39], v[40:43], v[96:111]
    v_mfma_f32_32x32x16_bf16 v[112:127], v[32:35], v[44:47], v[112:127]
    v_mfma_f32_32x32x16_bf16 v[112:127], v[36:39], v[44:47], v[112:127]
    ds_read_b128 v[32:35], v8 offset:3840
    ds_read_b128 v[36:39], v8 offset:8960
    ds_read_b128 v[40:43], v16 offset:256
    ds_read_b128 v[44:47], v17 offset:256
    s_waitcnt lgkmcnt(4)
    v_mfma_f32_32x32x16_bf16 v[96:111], v[48:51], v[56:59], v[96:111]
    v_mfma_f32_32x32x16_bf16 v[96:111], v[52:55], v[56:59], v[96:111]
    v_mfma_f32_32x32x16_bf16 v[112:127], v[48:51], v[60:63], v[112:127]
    v_mfma_f32_32x32x16_bf16 v[112:127], v[52:55], v[60:63], v[112:127]
    ds_read_b128 v[48:51], v8 offset:3968
    ds_read_b128 v[52:55], v8 offset:9088
    ds_read_b128 v[56:59], v16 offset:384
    ds_read_b128 v[60:63], v17 offset:384
    s_waitcnt lgkmcnt(4)
    v_mfma_f32_32x32x16_bf16 v[96:111], v[32:35], v[40:43], v[96:111]
    v_mfma_f32_32x32x16_bf16 v[96:111], v[36:39], v[40:43], v[96:111]
    v_mfma_f32_32x32x16_bf16 v[112:127], v[32:35], v[44:47], v[112:127]
    v_mfma_f32_32x32x16_bf16 v[112:127], v[36:39], v[44:47], v[112:127]
    v_add_u32 v14, 4294966720, v12
    v_cmp_le_u32 vcc, 1, v10
    s_nop 1
    v_cndmask_b32 v14, v13, v14, vcc
    v_add_u32 v15, 1728, v12
    ds_read_b128 v[32:35], v8 offset:3072
    ds_read_b128 v[36:39], v8 offset:8192
    ds_read_b128 v[40:43], v14 offset:0
    ds_read_b128 v[44:47], v15 offset:0
    s_waitcnt lgkmcnt(4)
    v_mfma_f32_32x32x16_bf16 v[96:111], v[48:51], v[56:59], v[96:111]
    v_mfma_f32_32x32x16_bf16 v[96:111], v[52:55], v[56:59], v[96:111]
    v_mfma_f32_32x32x16_bf16 v[112:127], v[48:51], v[60:63], v[112:127]
    v_mfma_f32_32x32x16_bf16 v[112:127], v[52:55], v[60:63], v[112:127]
    ds_read_b128 v[48:51], v8 offset:3200
    ds_read_b128 v[52:55], v8 offset:8320
    ds_read_b128 v[56:59], v14 offset:128
    ds_read_b128 v[60:63], v15 offset:128
    s_waitcnt lgkmcnt(4)
    v_mfma_f32_32x32x16_bf16 v[96:111], v[32:35], v[40:43], v[96:111]
    v_mfma_f32_32x32x16_bf16 v[96:111], v[36:39], v[40:43], v[96:111]
    v_mfma_f32_32x32x16_bf16 v[112:127], v[32:35], v[44:47], v[112:127]
    v_mfma_f32_32x32x16_bf16 v[112:127], v[36:39], v[44:47], v[112:127]
    ds_read_b128 v[32:35], v8 offset:3328
    ds_read_b128 v[36:39], v8 offset:8448
    ds_read_b128 v[40:43], v14 offset:256
    ds_read_b128 v[44:47], v15 offset:256
    s_waitcnt lgkmcnt(4)
    v_mfma_f32_32x32x16_bf16 v[96:111], v[48:51], v[56:59], v[96:111]
    v_mfma_f32_32x32x16_bf16 v[96:111], v[52:55], v[56:59], v[96:111]
    v_mfma_f32_32x32x16_bf16 v[112:127], v[48:51], v[60:63], v[112:127]
    v_mfma_f32_32x32x16_bf16 v[112:127], v[52:55], v[60:63], v[112:127]
    ds_read_b128 v[48:51], v8 offset:3456
    ds_read_b128 v[52:55], v8 offset:8576
    ds_read_b128 v[56:59], v14 offset:384
    ds_read_b128 v[60:63], v15 offset:384
    s_waitcnt lgkmcnt(4)
    v_mfma_f32_32x32x16_bf16 v[96:111], v[32:35], v[40:43], v[96:111]
    v_mfma_f32_32x32x16_bf16 v[96:111], v[36:39], v[40:43], v[96:111]
    v_mfma_f32_32x32x16_bf16 v[112:127], v[32:35], v[44:47], v[112:127]
    v_mfma_f32_32x32x16_bf16 v[112:127], v[36:39], v[44:47], v[112:127]
    v_add_u32 v16, 4294966144, v12
    v_cmp_le_u32 vcc, 2, v10
    s_nop 1
    v_cndmask_b32 v16, v13, v16, vcc
    v_add_u32 v17, 1152, v12
    ds_read_b128 v[32:35], v8 offset:2560
    ds_read_b128 v[36:39], v8 offset:7680
    ds_read_b128 v[40:43], v16 offset:0
    ds_read_b128 v[44:47], v17 offset:0
    s_waitcnt lgkmcnt(4)
    v_mfma_f32_32x32x16_bf16 v[96:111], v[48:51], v[56:59], v[96:111]
    v_mfma_f32_32x32x16_bf16 v[96:111], v[52:55], v[56:59], v[96:111]
    v_mfma_f32_32x32x16_bf16 v[112:127], v[48:51], v[60:63], v[112:127]
    v_mfma_f32_32x32x16_bf16 v[112:127], v[52:55], v[60:63], v[112:127]
    ds_read_b128 v[48:51], v8 offset:2688
    ds_read_b128 v[52:55], v8 offset:7808
    ds_read_b128 v[56:59], v16 offset:128
    ds_read_b128 v[60:63], v17 offset:128
    s_waitcnt lgkmcnt(4)
    v_mfma_f32_32x32x16_bf16 v[96:111], v[32:35], v[40:43], v[96:111]
    v_mfma_f32_32x32x16_bf16 v[96:111], v[36:39], v[40:43], v[96:111]
    v_mfma_f32_32x32x16_bf16 v[112:127], v[32:35], v[44:47], v[112:127]
    v_mfma_f32_32x32x16_bf16 v[112:127], v[36:39], v[44:47], v[112:127]
    ds_read_b128 v[32:35], v8 offset:2816
    ds_read_b128 v[36:39], v8 offset:7936
    ds_read_b128 v[40:43], v16 offset:256
    ds_read_b128 v[44:47], v17 offset:256
    s_waitcnt lgkmcnt(4)
    v_mfma_f32_32x32x16_bf16 v[96:111], v[48:51], v[56:59], v[96:111]
    v_mfma_f32_32x32x16_bf16 v[96:111], v[52:55], v[56:59], v[96:111]
    v_mfma_f32_32x32x16_bf16 v[112:127], v[48:51], v[60:63], v[112:127]
    v_mfma_f32_32x32x16_bf16 v[112:127], v[52:55], v[60:63], v[112:127]
    ds_read_b128 v[48:51], v8 offset:2944
    ds_read_b128 v[52:55], v8 offset:8064
    ds_read_b128 v[56:59], v16 offset:384
    ds_read_b128 v[60:63], v17 offset:384
    s_waitcnt lgkmcnt(4)
    v_mfma_f32_32x32x16_bf16 v[96:111], v[32:35], v[40:43], v[96:111]
    v_mfma_f32_32x32x16_bf16 v[96:111], v[36:39], v[40:43], v[96:111]
    v_mfma_f32_32x32x16_bf16 v[112:127], v[32:35], v[44:47], v[112:127]
    v_mfma_f32_32x32x16_bf16 v[112:127], v[36:39], v[44:47], v[112:127]
    v_add_u32 v14, 4294965568, v12
    v_cmp_le_u32 vcc, 3, v10
    s_nop 1
    v_cndmask_b32 v14, v13, v14, vcc
    v_add_u32 v15, 576, v12
    ds_read_b128 v[32:35], v8 offset:2048
    ds_read_b128 v[36:39], v8 offset:7168
    ds_read_b128 v[44:47], v15 offset:0
    s_waitcnt lgkmcnt(3)
    v_mfma_f32_32x32x16_bf16 v[96:111], v[48:51], v[56:59], v[96:111]
    v_mfma_f32_32x32x16_bf16 v[96:111], v[52:55], v[56:59], v[96:111]
    v_mfma_f32_32x32x16_bf16 v[112:127], v[48:51], v[60:63], v[112:127]
    v_mfma_f32_32x32x16_bf16 v[112:127], v[52:55], v[60:63], v[112:127]
    ds_read_b128 v[48:51], v8 offset:2176
    ds_read_b128 v[52:55], v8 offset:7296
    ds_read_b128 v[60:63], v15 offset:128
    s_waitcnt lgkmcnt(3)
    v_mfma_f32_32x32x16_bf16 v[112:127], v[32:35], v[44:47], v[112:127]
    v_mfma_f32_32x32x16_bf16 v[112:127], v[36:39], v[44:47], v[112:127]
    ds_read_b128 v[32:35], v8 offset:2304
    ds_read_b128 v[36:39], v8 offset:7424
    ds_read_b128 v[44:47], v15 offset:256
    s_waitcnt lgkmcnt(3)
    v_mfma_f32_32x32x16_bf16 v[112:127], v[48:51], v[60:63], v[112:127]
    v_mfma_f32_32x32x16_bf16 v[112:127], v[52:55], v[60:63], v[112:127]
    ds_read_b128 v[48:51], v8 offset:2432
    ds_read_b128 v[52:55], v8 offset:7552
    ds_read_b128 v[56:59], v14 offset:384
    ds_read_b128 v[60:63], v15 offset:384
    s_waitcnt lgkmcnt(4)
    v_mfma_f32_32x32x16_bf16 v[112:127], v[32:35], v[44:47], v[112:127]
    v_mfma_f32_32x32x16_bf16 v[112:127], v[36:39], v[44:47], v[112:127]
    v_add_u32 v17, 0, v12
    ds_read_b128 v[32:35], v8 offset:1536
    ds_read_b128 v[36:39], v8 offset:6656
    ds_read_b128 v[44:47], v17 offset:0
    s_waitcnt lgkmcnt(3)
    v_mfma_f32_32x32x16_bf16 v[96:111], v[48:51], v[56:59], v[96:111]
    v_mfma_f32_32x32x16_bf16 v[96:111], v[52:55], v[56:59], v[96:111]
    v_mfma_f32_32x32x16_bf16 v[112:127], v[48:51], v[60:63], v[112:127]
    v_mfma_f32_32x32x16_bf16 v[112:127], v[52:55], v[60:63], v[112:127]
    ds_read_b128 v[48:51], v8 offset:1664
    ds_read_b128 v[52:55], v8 offset:6784
    ds_read_b128 v[60:63], v17 offset:128
    s_waitcnt lgkmcnt(3)
    v_mfma_f32_32x32x16_bf16 v[112:127], v[32:35], v[44:47], v[112:127]
    v_mfma_f32_32x32x16_bf16 v[112:127], v[36:39], v[44:47], v[112:127]
    ds_read_b128 v[32:35], v8 offset:1792
    ds_read_b128 v[36:39], v8 offset:6912
    ds_read_b128 v[44:47], v17 offset:256
    s_waitcnt lgkmcnt(3)
    v_mfma_f32_32x32x16_bf16 v[112:127], v[48:51], v[60:63], v[112:127]
    v_mfma_f32_32x32x16_bf16 v[112:127], v[52:55], v[60:63], v[112:127]
    ds_read_b128 v[48:51], v8 offset:1920
    ds_read_b128 v[52:55], v8 offset:7040
    ds_read_b128 v[60:63], v17 offset:384
    s_waitcnt lgkmcnt(3)
    v_mfma_f32_32x32x16_bf16 v[112:127], v[32:35], v[44:47], v[112:127]
    v_mfma_f32_32x32x16_bf16 v[112:127], v[36:39], v[44:47], v[112:127]
    v_add_u32 v15, 4294966720, v12
    v_cmp_le_u32 vcc, 1, v10
    s_nop 1
    v_cndmask_b32 v15, v13, v15, vcc
    ds_read_b128 v[32:35], v8 offset:1024
    ds_read_b128 v[36:39], v8 offset:6144
    ds_read_b128 v[44:47], v15 offset:0
    s_waitcnt lgkmcnt(3)
    v_mfma_f32_32x32x16_bf16 v[112:127], v[48:51], v[60:63], v[112:127]
    v_mfma_f32_32x32x16_bf16 v[112:127], v[52:55], v[60:63], v[112:127]
    ds_read_b128 v[48:51], v8 offset:1152
    ds_read_b128 v[52:55], v8 offset:6272
    ds_read_b128 v[60:63], v15 offset:128
    s_waitcnt lgkmcnt(3)
    v_mfma_f32_32x32x16_bf16 v[112:127], v[32:35], v[44:47], v[112:127]
    v_mfma_f32_32x32x16_bf16 v[112:127], v[36:39], v[44:47], v[112:127]
    ds_read_b128 v[32:35], v8 offset:1280
    ds_read_b128 v[36:39], v8 offset:6400
    ds_read_b128 v[44:47], v15 offset:256
    s_waitcnt lgkmcnt(3)
    v_mfma_f32_32x32x16_bf16 v[112:127], v[48:51], v[60:63], v[112:127]
    v_mfma_f32_32x32x16_bf16 v[112:127], v[52:55], v[60:63], v[112:127]
    ds_read_b128 v[48:51], v8 offset:1408
    ds_read_b128 v[52:55], v8 offset:6528
    ds_read_b128 v[60:63], v15 offset:384
    s_waitcnt lgkmcnt(3)
    v_mfma_f32_32x32x16_bf16 v[112:127], v[32:35], v[44:47], v[112:127]
    v_mfma_f32_32x32x16_bf16 v[112:127], v[36:39], v[44:47], v[112:127]
    v_add_u32 v17, 4294966144, v12
    v_cmp_le_u32 vcc, 2, v10
    s_nop 1
    v_cndmask_b32 v17, v13, v17, vcc
    ds_read_b128 v[32:35], v8 offset:512
    ds_read_b128 v[36:39], v8 offset:5632
    ds_read_b128 v[44:47], v17 offset:0
    s_waitcnt lgkmcnt(3)
    v_mfma_f32_32x32x16_bf16 v[112:127], v[48:51], v[60:63], v[112:127]
    v_mfma_f32_32x32x16_bf16 v[112:127], v[52:55], v[60:63], v[112:127]
    ds_read_b128 v[48:51], v8 offset:640
    ds_read_b128 v[52:55], v8 offset:5760
    ds_read_b128 v[60:63], v17 offset:128
    s_waitcnt lgkmcnt(3)
    v_mfma_f32_32x32x16_bf16 v[112:127], v[32:35], v[44:47], v[112:127]
    v_mfma_f32_32x32x16_bf16 v[112:127], v[36:39], v[44:47], v[112:127]
    ds_read_b128 v[32:35], v8 offset:768
    ds_read_b128 v[36:39], v8 offset:5888
    ds_read_b128 v[44:47], v17 offset:256
    s_waitcnt lgkmcnt(3)
    v_mfma_f32_32x32x16_bf16 v[112:127], v[48:51], v[60:63], v[112:127]
    v_mfma_f32_32x32x16_bf16 v[112:127], v[52:55], v[60:63], v[112:127]
    ds_read_b128 v[48:51], v8 offset:896
    ds_read_b128 v[52:55], v8 offset:6016
    ds_read_b128 v[60:63], v17 offset:384
    s_waitcnt lgkmcnt(3)
    v_mfma_f32_32x32x16_bf16 v[112:127], v[32:35], v[44:47], v[112:127]
    v_mfma_f32_32x32x16_bf16 v[112:127], v[36:39], v[44:47], v[112:127]
    v_add_u32 v15, 4294965568, v12
    v_cmp_le_u32 vcc, 3, v10
    s_nop 1
    v_cndmask_b32 v15, v13, v15, vcc
    ds_read_b128 v[32:35], v8 offset:384
    ds_read_b128 v[36:39], v8 offset:5504
    ds_read_b128 v[44:47], v15 offset:384
    s_waitcnt lgkmcnt(3)
    v_mfma_f32_32x32x16_bf16 v[112:127], v[48:51], v[60:63], v[112:127]
    v_mfma_f32_32x32x16_bf16 v[112:127], v[52:55], v[60:63], v[112:127]
    s_waitcnt lgkmcnt(0)
    v_mfma_f32_32x32x16_bf16 v[112:127], v[32:35], v[44:47], v[112:127]
    v_mfma_f32_32x32x16_bf16 v[112:127], v[36:39], v[44:47], v[112:127]
    s_nop 15
    s_nop 7
    s_barrier
    v_lshlrev_b32 v14, 13, v2
    v_lshl_add_u32 v14, v10, 10, v14
    v_lshl_add_u32 v14, v11, 2, v14
    v_lshl_add_u32 v14, v4, 7, v14
    v_add_u32 v14, 50816, v14

    ds_write_b32 v14, v96 offset:0
    ds_write_b32 v14, v97 offset:32
    ds_write_b32 v14, v98 offset:64
    ds_write_b32 v14, v99 offset:96
    ds_write_b32 v14, v100 offset:256
    ds_write_b32 v14, v101 offset:288
    ds_write_b32 v14, v102 offset:320
    ds_write_b32 v14, v103 offset:352
    ds_write_b32 v14, v104 offset:512
    ds_write_b32 v14, v105 offset:544
    ds_write_b32 v14, v106 offset:576
    ds_write_b32 v14, v107 offset:608
    ds_write_b32 v14, v108 offset:768
    ds_write_b32 v14, v109 offset:800
    ds_write_b32 v14, v110 offset:832
    ds_write_b32 v14, v111 offset:864
    ds_write_b32 v14, v112 offset:4096
    ds_write_b32 v14, v113 offset:4128
    ds_write_b32 v14, v114 offset:4160
    ds_write_b32 v14, v115 offset:4192
    ds_write_b32 v14, v116 offset:4352
    ds_write_b32 v14, v117 offset:4384
    ds_write_b32 v14, v118 offset:4416
    ds_write_b32 v14, v119 offset:4448
    ds_write_b32 v14, v120 offset:4608
    ds_write_b32 v14, v121 offset:4640
    ds_write_b32 v14, v122 offset:4672
    ds_write_b32 v14, v123 offset:4704
    ds_write_b32 v14, v124 offset:4864
    ds_write_b32 v14, v125 offset:4896
    ds_write_b32 v14, v126 offset:4928
    ds_write_b32 v14, v127 offset:4960
    s_waitcnt lgkmcnt(0)
    s_barrier
    v_lshrrev_b32 v6, 8, v0
    v_and_b32 v7, 255, v0
    v_lshlrev_b32 v8, 15, v6
    v_lshl_add_u32 v8, v7, 5, v8
    v_add_u32 v8, 50816, v8
    v_mul_u32_u24 v9, 4672, v6
    v_lshl_add_u32 v9, v7, 4, v9
    s_lshl_b32 s23, s2, 2
    v_lshl_add_u32 v10, v6, 1, s23
    buffer_load_ushort v11, v10, s[32:35], 0 offen
    s_lshl_b32 s23, s2, 13
    v_lshlrev_b32 v10, 4, v0
    v_add_u32 v10, s23, v10
    v_add_u32 v12, 2097152, v10
    buffer_load_dwordx4 v[16:19], v12, s[36:39], 0 offen
    ds_read_b128 v[24:27], v9 offset:41472

    ds_read_b128 v[32:35], v8 offset:0
    ds_read_b128 v[36:39], v8 offset:16
    ds_read_b128 v[40:43], v8 offset:8192
    ds_read_b128 v[44:47], v8 offset:8208
    ds_read_b128 v[48:51], v8 offset:16384
    ds_read_b128 v[52:55], v8 offset:16400
    ds_read_b128 v[56:59], v8 offset:24576
    ds_read_b128 v[60:63], v8 offset:24592
    s_waitcnt vmcnt(0) lgkmcnt(0)
    v_lshlrev_b32 v11, 16, v11
    v_add_f32 v32, v32, v40
    v_add_f32 v33, v33, v41
    v_add_f32 v48, v48, v56
    v_add_f32 v49, v49, v57
    v_add_f32 v32, v32, v48
    v_add_f32 v33, v33, v49
    v_cvt_pk_bf16_f32 v12, v32, v33
    v_lshlrev_b32 v32, 16, v12
    v_and_b32 v33, 0xffff0000, v12
    v_lshlrev_b32 v13, 16, v24
    v_and_b32 v14, 0xffff0000, v24
    v_mul_f32 v13, v13, v11
    v_mul_f32 v14, v14, v11
    v_cvt_pk_bf16_f32 v12, v13, v14
    v_lshlrev_b32 v13, 16, v12
    v_and_b32 v14, 0xffff0000, v12
    v_add_f32 v32, v32, v13
    v_add_f32 v33, v33, v14
    v_cvt_pk_bf16_f32 v12, v32, v33
    v_lshlrev_b32 v13, 16, v12
    v_and_b32 v14, 0xffff0000, v12
    v_lshlrev_b32 v32, 16, v16
    v_and_b32 v33, 0xffff0000, v16
    v_add_f32 v32, v32, v13
    v_add_f32 v33, v33, v14
    v_cvt_pk_bf16_f32 v64, v32, v33

    v_add_f32 v34, v34, v42
    v_add_f32 v35, v35, v43
    v_add_f32 v50, v50, v58
    v_add_f32 v51, v51, v59
    v_add_f32 v34, v34, v50
    v_add_f32 v35, v35, v51
    v_cvt_pk_bf16_f32 v12, v34, v35
    v_lshlrev_b32 v34, 16, v12
    v_and_b32 v35, 0xffff0000, v12
    v_lshlrev_b32 v13, 16, v25
    v_and_b32 v14, 0xffff0000, v25
    v_mul_f32 v13, v13, v11
    v_mul_f32 v14, v14, v11
    v_cvt_pk_bf16_f32 v12, v13, v14
    v_lshlrev_b32 v13, 16, v12
    v_and_b32 v14, 0xffff0000, v12
    v_add_f32 v34, v34, v13
    v_add_f32 v35, v35, v14
    v_cvt_pk_bf16_f32 v12, v34, v35
    v_lshlrev_b32 v13, 16, v12
    v_and_b32 v14, 0xffff0000, v12
    v_lshlrev_b32 v34, 16, v17
    v_and_b32 v35, 0xffff0000, v17
    v_add_f32 v34, v34, v13
    v_add_f32 v35, v35, v14
    v_cvt_pk_bf16_f32 v65, v34, v35

    v_add_f32 v36, v36, v44
    v_add_f32 v37, v37, v45
    v_add_f32 v52, v52, v60
    v_add_f32 v53, v53, v61
    v_add_f32 v36, v36, v52
    v_add_f32 v37, v37, v53
    v_cvt_pk_bf16_f32 v12, v36, v37
    v_lshlrev_b32 v36, 16, v12
    v_and_b32 v37, 0xffff0000, v12
    v_lshlrev_b32 v13, 16, v26
    v_and_b32 v14, 0xffff0000, v26
    v_mul_f32 v13, v13, v11
    v_mul_f32 v14, v14, v11
    v_cvt_pk_bf16_f32 v12, v13, v14
    v_lshlrev_b32 v13, 16, v12
    v_and_b32 v14, 0xffff0000, v12
    v_add_f32 v36, v36, v13
    v_add_f32 v37, v37, v14
    v_cvt_pk_bf16_f32 v12, v36, v37
    v_lshlrev_b32 v13, 16, v12
    v_and_b32 v14, 0xffff0000, v12
    v_lshlrev_b32 v36, 16, v18
    v_and_b32 v37, 0xffff0000, v18
    v_add_f32 v36, v36, v13
    v_add_f32 v37, v37, v14
    v_cvt_pk_bf16_f32 v66, v36, v37

    v_add_f32 v38, v38, v46
    v_add_f32 v39, v39, v47
    v_add_f32 v54, v54, v62
    v_add_f32 v55, v55, v63
    v_add_f32 v38, v38, v54
    v_add_f32 v39, v39, v55
    v_cvt_pk_bf16_f32 v12, v38, v39
    v_lshlrev_b32 v38, 16, v12
    v_and_b32 v39, 0xffff0000, v12
    v_lshlrev_b32 v13, 16, v27
    v_and_b32 v14, 0xffff0000, v27
    v_mul_f32 v13, v13, v11
    v_mul_f32 v14, v14, v11
    v_cvt_pk_bf16_f32 v12, v13, v14
    v_lshlrev_b32 v13, 16, v12
    v_and_b32 v14, 0xffff0000, v12
    v_add_f32 v38, v38, v13
    v_add_f32 v39, v39, v14
    v_cvt_pk_bf16_f32 v12, v38, v39
    v_lshlrev_b32 v13, 16, v12
    v_and_b32 v14, 0xffff0000, v12
    v_lshlrev_b32 v38, 16, v19
    v_and_b32 v39, 0xffff0000, v19
    v_add_f32 v38, v38, v13
    v_add_f32 v39, v39, v14
    v_cvt_pk_bf16_f32 v67, v38, v39

    v_add_u32 v10, 8388608, v10
    buffer_store_dwordx4 v[64:67], v10, s[36:39], 0 offen

LB_done:
    s_endpgm
.section .rodata,"a"
.p2align 6
.amdhsa_kernel conv_kernel
  .amdhsa_next_free_vgpr 128
  .amdhsa_next_free_sgpr 102
  .amdhsa_accum_offset 128
  .amdhsa_group_segment_fixed_size 0
  .amdhsa_kernarg_size 120
  .amdhsa_user_sgpr_count 2
  .amdhsa_user_sgpr_kernarg_segment_ptr 1
  .amdhsa_system_sgpr_workgroup_id_x 1
.end_amdhsa_kernel
.text
.p2align 8
ln2_kernel:
    s_cmp_ge_u32 s2, 128
    s_cbranch_scc1 LC_done
    s_load_dwordx2 s[6:7], s[0:1], 112
    s_waitcnt lgkmcnt(0)

    s_mov_b32 s16, s6
    s_mov_b32 s17, s7
    s_mov_b32 s18, 33554432
    s_mov_b32 s19, 0x00020000
    v_and_b32 v1, 63, v0
    v_lshrrev_b32 v2, 6, v0
    s_lshl_b32 s21, s2, 5
    s_add_u32 s21, s21, 8388608
    v_lshlrev_b32 v3, 12, v0
    v_add_u32 v3, s21, v3
    v_add_u32 v4, 1048576, v3
    buffer_load_dwordx4 v[8:11], v3, s[16:19], 0 offen
    buffer_load_dwordx4 v[12:15], v3, s[16:19], 0 offen offset:16
    buffer_load_dwordx4 v[16:19], v4, s[16:19], 0 offen
    buffer_load_dwordx4 v[20:23], v4, s[16:19], 0 offen offset:16
    v_lshlrev_b32 v5, 1, v0
    s_waitcnt vmcnt(0)

    ds_write_b16 v5, v8 offset:0
    ds_write_b16_d16_hi v5, v8 offset:1040
    ds_write_b16 v5, v9 offset:2080
    ds_write_b16_d16_hi v5, v9 offset:3120
    ds_write_b16 v5, v10 offset:4160
    ds_write_b16_d16_hi v5, v10 offset:5200
    ds_write_b16 v5, v11 offset:6240
    ds_write_b16_d16_hi v5, v11 offset:7280
    ds_write_b16 v5, v12 offset:8320
    ds_write_b16_d16_hi v5, v12 offset:9360
    ds_write_b16 v5, v13 offset:10400
    ds_write_b16_d16_hi v5, v13 offset:11440
    ds_write_b16 v5, v14 offset:12480
    ds_write_b16_d16_hi v5, v14 offset:13520
    ds_write_b16 v5, v15 offset:14560
    ds_write_b16_d16_hi v5, v15 offset:15600
    ds_write_b16 v5, v16 offset:512
    ds_write_b16_d16_hi v5, v16 offset:1552
    ds_write_b16 v5, v17 offset:2592
    ds_write_b16_d16_hi v5, v17 offset:3632
    ds_write_b16 v5, v18 offset:4672
    ds_write_b16_d16_hi v5, v18 offset:5712
    ds_write_b16 v5, v19 offset:6752
    ds_write_b16_d16_hi v5, v19 offset:7792
    ds_write_b16 v5, v20 offset:8832
    ds_write_b16_d16_hi v5, v20 offset:9872
    ds_write_b16 v5, v21 offset:10912
    ds_write_b16_d16_hi v5, v21 offset:11952
    ds_write_b16 v5, v22 offset:12992
    ds_write_b16_d16_hi v5, v22 offset:14032
    ds_write_b16 v5, v23 offset:15072
    ds_write_b16_d16_hi v5, v23 offset:16112
    s_waitcnt lgkmcnt(0)
    s_barrier
    v_mul_u32_u24 v3, 4160, v2
    v_lshl_add_u32 v3, v1, 4, v3
    ds_read_b128 v[8:11], v3
    ds_read_b128 v[12:15], v3 offset:1040
    ds_read_b128 v[16:19], v3 offset:2080
    ds_read_b128 v[20:23], v3 offset:3120

    v_xor_b32 v24, 1, v1
    v_lshlrev_b32 v24, 2, v24
    v_xor_b32 v25, 2, v1
    v_lshlrev_b32 v25, 2, v25
    v_xor_b32 v26, 4, v1
    v_lshlrev_b32 v26, 2, v26
    v_xor_b32 v27, 8, v1
    v_lshlrev_b32 v27, 2, v27
    v_xor_b32 v28, 16, v1
    v_lshlrev_b32 v28, 2, v28
    v_xor_b32 v29, 32, v1
    v_lshlrev_b32 v29, 2, v29
    s_waitcnt lgkmcnt(0)
    v_lshlrev_b32 v32, 16, v8
    v_and_b32 v33, 0xffff0000, v8
    v_lshlrev_b32 v34, 16, v9
    v_and_b32 v35, 0xffff0000, v9
    v_lshlrev_b32 v36, 16, v10
    v_and_b32 v37, 0xffff0000, v10
    v_lshlrev_b32 v38, 16, v11
    v_and_b32 v39, 0xffff0000, v11
    v_lshlrev_b32 v40, 16, v12
    v_and_b32 v41, 0xffff0000, v12
    v_lshlrev_b32 v42, 16, v13
    v_and_b32 v43, 0xffff0000, v13
    v_lshlrev_b32 v44, 16, v14
    v_and_b32 v45, 0xffff0000, v14
    v_lshlrev_b32 v46, 16, v15
    v_and_b32 v47, 0xffff0000, v15
    v_lshlrev_b32 v48, 16, v16
    v_and_b32 v49, 0xffff0000, v16
    v_lshlrev_b32 v50, 16, v17
    v_and_b32 v51, 0xffff0000, v17
    v_lshlrev_b32 v52, 16, v18
    v_and_b32 v53, 0xffff0000, v18
    v_lshlrev_b32 v54, 16, v19
    v_and_b32 v55, 0xffff0000, v19
    v_lshlrev_b32 v56, 16, v20
    v_and_b32 v57, 0xffff0000, v20
    v_lshlrev_b32 v58, 16, v21
    v_and_b32 v59, 0xffff0000, v21
    v_lshlrev_b32 v60, 16, v22
    v_and_b32 v61, 0xffff0000, v22
    v_lshlrev_b32 v62, 16, v23
    v_and_b32 v63, 0xffff0000, v23
    v_add_f32 v64, v32, v33
    v_add_f32 v64, v64, v34
    v_add_f32 v64, v64, v35
    v_add_f32 v64, v64, v36
    v_add_f32 v64, v64, v37
    v_add_f32 v64, v64, v38
    v_add_f32 v64, v64, v39
    v_add_f32 v65, v40, v41
    v_add_f32 v65, v65, v42
    v_add_f32 v65, v65, v43
    v_add_f32 v65, v65, v44
    v_add_f32 v65, v65, v45
    v_add_f32 v65, v65, v46
    v_add_f32 v65, v65, v47
    v_add_f32 v66, v48, v49
    v_add_f32 v66, v66, v50
    v_add_f32 v66, v66, v51
    v_add_f32 v66, v66, v52
    v_add_f32 v66, v66, v53
    v_add_f32 v66, v66, v54
    v_add_f32 v66, v66, v55
    v_add_f32 v67, v56, v57
    v_add_f32 v67, v67, v58
    v_add_f32 v67, v67, v59
    v_add_f32 v67, v67, v60
    v_add_f32 v67, v67, v61
    v_add_f32 v67, v67, v62
    v_add_f32 v67, v67, v63
    ds_bpermute_b32 v72, v24, v64
    ds_bpermute_b32 v73, v24, v65
    ds_bpermute_b32 v74, v24, v66
    ds_bpermute_b32 v75, v24, v67
    s_waitcnt lgkmcnt(0)
    v_add_f32 v64, v64, v72
    v_add_f32 v65, v65, v73
    v_add_f32 v66, v66, v74
    v_add_f32 v67, v67, v75
    ds_bpermute_b32 v72, v25, v64
    ds_bpermute_b32 v73, v25, v65
    ds_bpermute_b32 v74, v25, v66
    ds_bpermute_b32 v75, v25, v67
    s_waitcnt lgkmcnt(0)
    v_add_f32 v64, v64, v72
    v_add_f32 v65, v65, v73
    v_add_f32 v66, v66, v74
    v_add_f32 v67, v67, v75
    ds_bpermute_b32 v72, v26, v64
    ds_bpermute_b32 v73, v26, v65
    ds_bpermute_b32 v74, v26, v66
    ds_bpermute_b32 v75, v26, v67
    s_waitcnt lgkmcnt(0)
    v_add_f32 v64, v64, v72
    v_add_f32 v65, v65, v73
    v_add_f32 v66, v66, v74
    v_add_f32 v67, v67, v75
    ds_bpermute_b32 v72, v27, v64
    ds_bpermute_b32 v73, v27, v65
    ds_bpermute_b32 v74, v27, v66
    ds_bpermute_b32 v75, v27, v67
    s_waitcnt lgkmcnt(0)
    v_add_f32 v64, v64, v72
    v_add_f32 v65, v65, v73
    v_add_f32 v66, v66, v74
    v_add_f32 v67, v67, v75
    ds_bpermute_b32 v72, v28, v64
    ds_bpermute_b32 v73, v28, v65
    ds_bpermute_b32 v74, v28, v66
    ds_bpermute_b32 v75, v28, v67
    s_waitcnt lgkmcnt(0)
    v_add_f32 v64, v64, v72
    v_add_f32 v65, v65, v73
    v_add_f32 v66, v66, v74
    v_add_f32 v67, v67, v75
    ds_bpermute_b32 v72, v29, v64
    ds_bpermute_b32 v73, v29, v65
    ds_bpermute_b32 v74, v29, v66
    ds_bpermute_b32 v75, v29, v67
    s_waitcnt lgkmcnt(0)
    v_add_f32 v64, v64, v72
    v_add_f32 v65, v65, v73
    v_add_f32 v66, v66, v74
    v_add_f32 v67, v67, v75
    v_mul_f32 v64, 0x3b000000, v64
    v_mov_b32 v68, 0
    v_sub_f32 v76, v32, v64
    v_fmac_f32 v68, v76, v76
    v_sub_f32 v76, v33, v64
    v_fmac_f32 v68, v76, v76
    v_sub_f32 v76, v34, v64
    v_fmac_f32 v68, v76, v76
    v_sub_f32 v76, v35, v64
    v_fmac_f32 v68, v76, v76
    v_sub_f32 v76, v36, v64
    v_fmac_f32 v68, v76, v76
    v_sub_f32 v76, v37, v64
    v_fmac_f32 v68, v76, v76
    v_sub_f32 v76, v38, v64
    v_fmac_f32 v68, v76, v76
    v_sub_f32 v76, v39, v64
    v_fmac_f32 v68, v76, v76
    v_mul_f32 v65, 0x3b000000, v65
    v_mov_b32 v69, 0
    v_sub_f32 v76, v40, v65
    v_fmac_f32 v69, v76, v76
    v_sub_f32 v76, v41, v65
    v_fmac_f32 v69, v76, v76
    v_sub_f32 v76, v42, v65
    v_fmac_f32 v69, v76, v76
    v_sub_f32 v76, v43, v65
    v_fmac_f32 v69, v76, v76
    v_sub_f32 v76, v44, v65
    v_fmac_f32 v69, v76, v76
    v_sub_f32 v76, v45, v65
    v_fmac_f32 v69, v76, v76
    v_sub_f32 v76, v46, v65
    v_fmac_f32 v69, v76, v76
    v_sub_f32 v76, v47, v65
    v_fmac_f32 v69, v76, v76
    v_mul_f32 v66, 0x3b000000, v66
    v_mov_b32 v70, 0
    v_sub_f32 v76, v48, v66
    v_fmac_f32 v70, v76, v76
    v_sub_f32 v76, v49, v66
    v_fmac_f32 v70, v76, v76
    v_sub_f32 v76, v50, v66
    v_fmac_f32 v70, v76, v76
    v_sub_f32 v76, v51, v66
    v_fmac_f32 v70, v76, v76
    v_sub_f32 v76, v52, v66
    v_fmac_f32 v70, v76, v76
    v_sub_f32 v76, v53, v66
    v_fmac_f32 v70, v76, v76
    v_sub_f32 v76, v54, v66
    v_fmac_f32 v70, v76, v76
    v_sub_f32 v76, v55, v66
    v_fmac_f32 v70, v76, v76
    v_mul_f32 v67, 0x3b000000, v67
    v_mov_b32 v71, 0
    v_sub_f32 v76, v56, v67
    v_fmac_f32 v71, v76, v76
    v_sub_f32 v76, v57, v67
    v_fmac_f32 v71, v76, v76
    v_sub_f32 v76, v58, v67
    v_fmac_f32 v71, v76, v76
    v_sub_f32 v76, v59, v67
    v_fmac_f32 v71, v76, v76
    v_sub_f32 v76, v60, v67
    v_fmac_f32 v71, v76, v76
    v_sub_f32 v76, v61, v67
    v_fmac_f32 v71, v76, v76
    v_sub_f32 v76, v62, v67
    v_fmac_f32 v71, v76, v76
    v_sub_f32 v76, v63, v67
    v_fmac_f32 v71, v76, v76
    ds_bpermute_b32 v72, v24, v68
    ds_bpermute_b32 v73, v24, v69
    ds_bpermute_b32 v74, v24, v70
    ds_bpermute_b32 v75, v24, v71
    s_waitcnt lgkmcnt(0)
    v_add_f32 v68, v68, v72
    v_add_f32 v69, v69, v73
    v_add_f32 v70, v70, v74
    v_add_f32 v71, v71, v75
    ds_bpermute_b32 v72, v25, v68
    ds_bpermute_b32 v73, v25, v69
    ds_bpermute_b32 v74, v25, v70
    ds_bpermute_b32 v75, v25, v71
    s_waitcnt lgkmcnt(0)
    v_add_f32 v68, v68, v72
    v_add_f32 v69, v69, v73
    v_add_f32 v70, v70, v74
    v_add_f32 v71, v71, v75
    ds_bpermute_b32 v72, v26, v68
    ds_bpermute_b32 v73, v26, v69
    ds_bpermute_b32 v74, v26, v70
    ds_bpermute_b32 v75, v26, v71
    s_waitcnt lgkmcnt(0)
    v_add_f32 v68, v68, v72
    v_add_f32 v69, v69, v73
    v_add_f32 v70, v70, v74
    v_add_f32 v71, v71, v75
    ds_bpermute_b32 v72, v27, v68
    ds_bpermute_b32 v73, v27, v69
    ds_bpermute_b32 v74, v27, v70
    ds_bpermute_b32 v75, v27, v71
    s_waitcnt lgkmcnt(0)
    v_add_f32 v68, v68, v72
    v_add_f32 v69, v69, v73
    v_add_f32 v70, v70, v74
    v_add_f32 v71, v71, v75
    ds_bpermute_b32 v72, v28, v68
    ds_bpermute_b32 v73, v28, v69
    ds_bpermute_b32 v74, v28, v70
    ds_bpermute_b32 v75, v28, v71
    s_waitcnt lgkmcnt(0)
    v_add_f32 v68, v68, v72
    v_add_f32 v69, v69, v73
    v_add_f32 v70, v70, v74
    v_add_f32 v71, v71, v75
    ds_bpermute_b32 v72, v29, v68
    ds_bpermute_b32 v73, v29, v69
    ds_bpermute_b32 v74, v29, v70
    ds_bpermute_b32 v75, v29, v71
    s_waitcnt lgkmcnt(0)
    v_add_f32 v68, v68, v72
    v_add_f32 v69, v69, v73
    v_add_f32 v70, v70, v74
    v_add_f32 v71, v71, v75
    s_lshl_b32 s20, s2, 14
    s_add_u32 s20, s20, 18874368
    v_lshlrev_b32 v3, 12, v2
    v_lshl_add_u32 v3, v1, 4, v3
    v_add_u32 v3, s20, v3

    v_mul_f32 v68, 0x3b000000, v68
    v_cvt_pk_bf16_f32 v64, v64, v64
    v_lshlrev_b32 v64, 16, v64
    v_cvt_pk_bf16_f32 v68, v68, v68
    v_lshlrev_b32 v68, 16, v68
    v_add_f32 v68, 0x3727c5ac, v68
    v_cvt_pk_bf16_f32 v68, v68, v68
    v_lshlrev_b32 v68, 16, v68
    v_sqrt_f32 v68, v68
    s_nop 0
    v_cvt_pk_bf16_f32 v68, v68, v68
    v_lshlrev_b32 v68, 16, v68
    v_rcp_f32 v68, v68
    s_nop 0
    v_sub_f32 v32, v32, v64
    v_sub_f32 v33, v33, v64
    v_cvt_pk_bf16_f32 v76, v32, v33
    v_lshlrev_b32 v32, 16, v76
    v_and_b32 v33, 0xffff0000, v76
    v_mul_f32 v32, v32, v68
    v_mul_f32 v33, v33, v68
    v_cvt_pk_bf16_f32 v80, v32, v33
    v_sub_f32 v34, v34, v64
    v_sub_f32 v35, v35, v64
    v_cvt_pk_bf16_f32 v76, v34, v35
    v_lshlrev_b32 v34, 16, v76
    v_and_b32 v35, 0xffff0000, v76
    v_mul_f32 v34, v34, v68
    v_mul_f32 v35, v35, v68
    v_cvt_pk_bf16_f32 v81, v34, v35
    v_sub_f32 v36, v36, v64
    v_sub_f32 v37, v37, v64
    v_cvt_pk_bf16_f32 v76, v36, v37
    v_lshlrev_b32 v36, 16, v76
    v_and_b32 v37, 0xffff0000, v76
    v_mul_f32 v36, v36, v68
    v_mul_f32 v37, v37, v68
    v_cvt_pk_bf16_f32 v82, v36, v37
    v_sub_f32 v38, v38, v64
    v_sub_f32 v39, v39, v64
    v_cvt_pk_bf16_f32 v76, v38, v39
    v_lshlrev_b32 v38, 16, v76
    v_and_b32 v39, 0xffff0000, v76
    v_mul_f32 v38, v38, v68
    v_mul_f32 v39, v39, v68
    v_cvt_pk_bf16_f32 v83, v38, v39
    buffer_store_dwordx4 v[80:83], v3, s[16:19], 0 offen offset:0
    v_mul_f32 v69, 0x3b000000, v69
    v_cvt_pk_bf16_f32 v65, v65, v65
    v_lshlrev_b32 v65, 16, v65
    v_cvt_pk_bf16_f32 v69, v69, v69
    v_lshlrev_b32 v69, 16, v69
    v_add_f32 v69, 0x3727c5ac, v69
    v_cvt_pk_bf16_f32 v69, v69, v69
    v_lshlrev_b32 v69, 16, v69
    v_sqrt_f32 v69, v69
    s_nop 0
    v_cvt_pk_bf16_f32 v69, v69, v69
    v_lshlrev_b32 v69, 16, v69
    v_rcp_f32 v69, v69
    s_nop 0
    v_sub_f32 v40, v40, v65
    v_sub_f32 v41, v41, v65
    v_cvt_pk_bf16_f32 v76, v40, v41
    v_lshlrev_b32 v40, 16, v76
    v_and_b32 v41, 0xffff0000, v76
    v_mul_f32 v40, v40, v69
    v_mul_f32 v41, v41, v69
    v_cvt_pk_bf16_f32 v84, v40, v41
    v_sub_f32 v42, v42, v65
    v_sub_f32 v43, v43, v65
    v_cvt_pk_bf16_f32 v76, v42, v43
    v_lshlrev_b32 v42, 16, v76
    v_and_b32 v43, 0xffff0000, v76
    v_mul_f32 v42, v42, v69
    v_mul_f32 v43, v43, v69
    v_cvt_pk_bf16_f32 v85, v42, v43
    v_sub_f32 v44, v44, v65
    v_sub_f32 v45, v45, v65
    v_cvt_pk_bf16_f32 v76, v44, v45
    v_lshlrev_b32 v44, 16, v76
    v_and_b32 v45, 0xffff0000, v76
    v_mul_f32 v44, v44, v69
    v_mul_f32 v45, v45, v69
    v_cvt_pk_bf16_f32 v86, v44, v45
    v_sub_f32 v46, v46, v65
    v_sub_f32 v47, v47, v65
    v_cvt_pk_bf16_f32 v76, v46, v47
    v_lshlrev_b32 v46, 16, v76
    v_and_b32 v47, 0xffff0000, v76
    v_mul_f32 v46, v46, v69
    v_mul_f32 v47, v47, v69
    v_cvt_pk_bf16_f32 v87, v46, v47
    buffer_store_dwordx4 v[84:87], v3, s[16:19], 0 offen offset:1024
    v_mul_f32 v70, 0x3b000000, v70
    v_cvt_pk_bf16_f32 v66, v66, v66
    v_lshlrev_b32 v66, 16, v66
    v_cvt_pk_bf16_f32 v70, v70, v70
    v_lshlrev_b32 v70, 16, v70
    v_add_f32 v70, 0x3727c5ac, v70
    v_cvt_pk_bf16_f32 v70, v70, v70
    v_lshlrev_b32 v70, 16, v70
    v_sqrt_f32 v70, v70
    s_nop 0
    v_cvt_pk_bf16_f32 v70, v70, v70
    v_lshlrev_b32 v70, 16, v70
    v_rcp_f32 v70, v70
    s_nop 0
    v_sub_f32 v48, v48, v66
    v_sub_f32 v49, v49, v66
    v_cvt_pk_bf16_f32 v76, v48, v49
    v_lshlrev_b32 v48, 16, v76
    v_and_b32 v49, 0xffff0000, v76
    v_mul_f32 v48, v48, v70
    v_mul_f32 v49, v49, v70
    v_cvt_pk_bf16_f32 v88, v48, v49
    v_sub_f32 v50, v50, v66
    v_sub_f32 v51, v51, v66
    v_cvt_pk_bf16_f32 v76, v50, v51
    v_lshlrev_b32 v50, 16, v76
    v_and_b32 v51, 0xffff0000, v76
    v_mul_f32 v50, v50, v70
    v_mul_f32 v51, v51, v70
    v_cvt_pk_bf16_f32 v89, v50, v51
    v_sub_f32 v52, v52, v66
    v_sub_f32 v53, v53, v66
    v_cvt_pk_bf16_f32 v76, v52, v53
    v_lshlrev_b32 v52, 16, v76
    v_and_b32 v53, 0xffff0000, v76
    v_mul_f32 v52, v52, v70
    v_mul_f32 v53, v53, v70
    v_cvt_pk_bf16_f32 v90, v52, v53
    v_sub_f32 v54, v54, v66
    v_sub_f32 v55, v55, v66
    v_cvt_pk_bf16_f32 v76, v54, v55
    v_lshlrev_b32 v54, 16, v76
    v_and_b32 v55, 0xffff0000, v76
    v_mul_f32 v54, v54, v70
    v_mul_f32 v55, v55, v70
    v_cvt_pk_bf16_f32 v91, v54, v55
    buffer_store_dwordx4 v[88:91], v3, s[16:19], 0 offen offset:2048
    v_mul_f32 v71, 0x3b000000, v71
    v_cvt_pk_bf16_f32 v67, v67, v67
    v_lshlrev_b32 v67, 16, v67
    v_cvt_pk_bf16_f32 v71, v71, v71
    v_lshlrev_b32 v71, 16, v71
    v_add_f32 v71, 0x3727c5ac, v71
    v_cvt_pk_bf16_f32 v71, v71, v71
    v_lshlrev_b32 v71, 16, v71
    v_sqrt_f32 v71, v71
    s_nop 0
    v_cvt_pk_bf16_f32 v71, v71, v71
    v_lshlrev_b32 v71, 16, v71
    v_rcp_f32 v71, v71
    s_nop 0
    v_sub_f32 v56, v56, v67
    v_sub_f32 v57, v57, v67
    v_cvt_pk_bf16_f32 v76, v56, v57
    v_lshlrev_b32 v56, 16, v76
    v_and_b32 v57, 0xffff0000, v76
    v_mul_f32 v56, v56, v71
    v_mul_f32 v57, v57, v71
    v_cvt_pk_bf16_f32 v92, v56, v57
    v_sub_f32 v58, v58, v67
    v_sub_f32 v59, v59, v67
    v_cvt_pk_bf16_f32 v76, v58, v59
    v_lshlrev_b32 v58, 16, v76
    v_and_b32 v59, 0xffff0000, v76
    v_mul_f32 v58, v58, v71
    v_mul_f32 v59, v59, v71
    v_cvt_pk_bf16_f32 v93, v58, v59
    v_sub_f32 v60, v60, v67
    v_sub_f32 v61, v61, v67
    v_cvt_pk_bf16_f32 v76, v60, v61
    v_lshlrev_b32 v60, 16, v76
    v_and_b32 v61, 0xffff0000, v76
    v_mul_f32 v60, v60, v71
    v_mul_f32 v61, v61, v71
    v_cvt_pk_bf16_f32 v94, v60, v61
    v_sub_f32 v62, v62, v67
    v_sub_f32 v63, v63, v67
    v_cvt_pk_bf16_f32 v76, v62, v63
    v_lshlrev_b32 v62, 16, v76
    v_and_b32 v63, 0xffff0000, v76
    v_mul_f32 v62, v62, v71
    v_mul_f32 v63, v63, v71
    v_cvt_pk_bf16_f32 v95, v62, v63
    buffer_store_dwordx4 v[92:95], v3, s[16:19], 0 offen offset:3072
LC_done:
    s_endpgm
.section .rodata,"a"
.p2align 6
.amdhsa_kernel ln2_kernel
  .amdhsa_next_free_vgpr 96
  .amdhsa_next_free_sgpr 102
  .amdhsa_accum_offset 96
  .amdhsa_group_segment_fixed_size 0
  .amdhsa_kernarg_size 120
  .amdhsa_user_sgpr_count 2
  .amdhsa_user_sgpr_kernarg_segment_ptr 1
  .amdhsa_system_sgpr_workgroup_id_x 1
.end_amdhsa_kernel
.text
.p2align 8
ffn1_kernel:
    s_cmp_ge_u32 s2, 256
    s_cbranch_scc1 LD_done
    s_load_dwordx2 s[4:5], s[0:1], 112
    s_waitcnt lgkmcnt(0)

    s_mov_b32 s8, s4
    s_mov_b32 s9, s5
    s_mov_b32 s10, 33554432
    s_mov_b32 s11, 0x00020000
    s_and_b32 s12, s2, 7
    s_lshl_b32 s12, s12, 1
    s_lshr_b32 s13, s2, 7
    s_add_u32 s12, s12, s13
    s_bfe_u32 s13, s2, 0x40003
    v_and_b32 v1, 15, v0
    v_bfe_u32 v2, v0, 4, 2
    v_lshrrev_b32 v3, 6, v0
    v_lshrrev_b32 v16, 3, v0
    v_and_b32 v17, 7, v0
    v_lshlrev_b32 v18, 10, v16
    v_lshl_add_u32 v18, v17, 4, v18
    s_lshl_b32 s14, s12, 17
    s_add_u32 s14, s14, 18874368
    v_add_u32 v19, s14, v18
    s_mul_i32 s15, s13, 114688
    s_add_u32 s15, s15, 4194304
    v_add_u32 v20, s15, v18
    v_mul_u32_u24 v21, 144, v16
    v_lshl_add_u32 v21, v17, 4, v21
    v_add_u32 v25, 18432, v21
    v_lshl_add_u32 v22, v3, 5, v1
    v_mul_u32_u24 v22, 144, v22
    v_lshl_add_u32 v22, v2, 4, v22
    v_mul_u32_u24 v23, 144, v1
    v_lshl_add_u32 v23, v2, 4, v23
    v_add_u32 v23, 18432, v23
    v_cmp_gt_u32 vcc, 128, v0
    s_mov_b64 s[22:23], vcc

    v_mov_b32 v32, 0
    v_mov_b32 v33, 0
    v_mov_b32 v34, 0
    v_mov_b32 v35, 0
    v_mov_b32 v36, 0
    v_mov_b32 v37, 0
    v_mov_b32 v38, 0
    v_mov_b32 v39, 0
    v_mov_b32 v40, 0
    v_mov_b32 v41, 0
    v_mov_b32 v42, 0
    v_mov_b32 v43, 0
    v_mov_b32 v44, 0
    v_mov_b32 v45, 0
    v_mov_b32 v46, 0
    v_mov_b32 v47, 0
    v_mov_b32 v48, 0
    v_mov_b32 v49, 0
    v_mov_b32 v50, 0
    v_mov_b32 v51, 0
    v_mov_b32 v52, 0
    v_mov_b32 v53, 0
    v_mov_b32 v54, 0
    v_mov_b32 v55, 0
    v_mov_b32 v56, 0
    v_mov_b32 v57, 0
    v_mov_b32 v58, 0
    v_mov_b32 v59, 0
    v_mov_b32 v60, 0
    v_mov_b32 v61, 0
    v_mov_b32 v62, 0
    v_mov_b32 v63, 0
    v_mov_b32 v64, 0
    v_mov_b32 v65, 0
    v_mov_b32 v66, 0
    v_mov_b32 v67, 0
    v_mov_b32 v68, 0
    v_mov_b32 v69, 0
    v_mov_b32 v70, 0
    v_mov_b32 v71, 0
    v_mov_b32 v72, 0
    v_mov_b32 v73, 0
    v_mov_b32 v74, 0
    v_mov_b32 v75, 0
    v_mov_b32 v76, 0
    v_mov_b32 v77, 0
    v_mov_b32 v78, 0
    v_mov_b32 v79, 0
    v_mov_b32 v80, 0
    v_mov_b32 v81, 0
    v_mov_b32 v82, 0
    v_mov_b32 v83, 0
    v_mov_b32 v84, 0
    v_mov_b32 v85, 0
    v_mov_b32 v86, 0
    v_mov_b32 v87, 0
    v_add_u32 v24, 0, v19
    buffer_load_dwordx4 v[88:91], v24, s[8:11], 0 offen offset:0
    v_add_u32 v24, 32768, v19
    buffer_load_dwordx4 v[92:95], v24, s[8:11], 0 offen offset:0
    v_add_u32 v24, 65536, v19
    buffer_load_dwordx4 v[96:99], v24, s[8:11], 0 offen offset:0
    v_add_u32 v24, 98304, v19
    buffer_load_dwordx4 v[100:103], v24, s[8:11], 0 offen offset:0
    v_add_u32 v24, 0, v20
    buffer_load_dwordx4 v[104:107], v24, s[8:11], 0 offen offset:0
    v_add_u32 v24, 32768, v20
    buffer_load_dwordx4 v[108:111], v24, s[8:11], 0 offen offset:0
    v_add_u32 v24, 65536, v20
    buffer_load_dwordx4 v[112:115], v24, s[8:11], 0 offen offset:0
    s_mov_b64 exec, s[22:23]
    v_add_u32 v24, 98304, v20
    buffer_load_dwordx4 v[116:119], v24, s[8:11], 0 offen offset:0
    s_mov_b64 exec, -1
    v_add_u32 v24, 0, v19
    buffer_load_dwordx4 v[120:123], v24, s[8:11], 0 offen offset:128
    v_add_u32 v24, 32768, v19
    buffer_load_dwordx4 v[124:127], v24, s[8:11], 0 offen offset:128
    v_add_u32 v24, 65536, v19
    buffer_load_dwordx4 v[128:131], v24, s[8:11], 0 offen offset:128
    v_add_u32 v24, 98304, v19
    buffer_load_dwordx4 v[132:135], v24, s[8:11], 0 offen offset:128
    v_add_u32 v24, 0, v20
    buffer_load_dwordx4 v[136:139], v24, s[8:11], 0 offen offset:128
    v_add_u32 v24, 32768, v20
    buffer_load_dwordx4 v[140:143], v24, s[8:11], 0 offen offset:128
    v_add_u32 v24, 65536, v20
    buffer_load_dwordx4 v[144:147], v24, s[8:11], 0 offen offset:128
    s_mov_b64 exec, s[22:23]
    v_add_u32 v24, 98304, v20
    buffer_load_dwordx4 v[148:151], v24, s[8:11], 0 offen offset:128
    s_mov_b64 exec, -1
    v_add_u32 v24, 0, v19
    buffer_load_dwordx4 v[152:155], v24, s[8:11], 0 offen offset:256
    v_add_u32 v24, 32768, v19
    buffer_load_dwordx4 v[156:159], v24, s[8:11], 0 offen offset:256
    v_add_u32 v24, 65536, v19
    buffer_load_dwordx4 v[160:163], v24, s[8:11], 0 offen offset:256
    v_add_u32 v24, 98304, v19
    buffer_load_dwordx4 v[164:167], v24, s[8:11], 0 offen offset:256
    v_add_u32 v24, 0, v20
    buffer_load_dwordx4 v[168:171], v24, s[8:11], 0 offen offset:256
    v_add_u32 v24, 32768, v20
    buffer_load_dwordx4 v[172:175], v24, s[8:11], 0 offen offset:256
    v_add_u32 v24, 65536, v20
    buffer_load_dwordx4 v[176:179], v24, s[8:11], 0 offen offset:256
    s_mov_b64 exec, s[22:23]
    v_add_u32 v24, 98304, v20
    buffer_load_dwordx4 v[180:183], v24, s[8:11], 0 offen offset:256
    s_mov_b64 exec, -1
    s_waitcnt vmcnt(16)
    ds_write_b128 v21, v[88:91] offset:0
    ds_write_b128 v21, v[92:95] offset:4608
    ds_write_b128 v21, v[96:99] offset:9216
    ds_write_b128 v21, v[100:103] offset:13824
    ds_write_b128 v25, v[104:107] offset:0
    ds_write_b128 v25, v[108:111] offset:4608
    ds_write_b128 v25, v[112:115] offset:9216
    s_mov_b64 exec, s[22:23]
    ds_write_b128 v25, v[116:119] offset:13824
    s_mov_b64 exec, -1
    s_waitcnt lgkmcnt(0)
    s_barrier
    v_add_u32 v24, 0, v19
    buffer_load_dwordx4 v[88:91], v24, s[8:11], 0 offen offset:384
    v_add_u32 v24, 32768, v19
    buffer_load_dwordx4 v[92:95], v24, s[8:11], 0 offen offset:384
    v_add_u32 v24, 65536, v19
    buffer_load_dwordx4 v[96:99], v24, s[8:11], 0 offen offset:384
    v_add_u32 v24, 98304, v19
    buffer_load_dwordx4 v[100:103], v24, s[8:11], 0 offen offset:384
    v_add_u32 v24, 0, v20
    buffer_load_dwordx4 v[104:107], v24, s[8:11], 0 offen offset:384
    v_add_u32 v24, 32768, v20
    buffer_load_dwordx4 v[108:111], v24, s[8:11], 0 offen offset:384
    v_add_u32 v24, 65536, v20
    buffer_load_dwordx4 v[112:115], v24, s[8:11], 0 offen offset:384
    s_mov_b64 exec, s[22:23]
    v_add_u32 v24, 98304, v20
    buffer_load_dwordx4 v[116:119], v24, s[8:11], 0 offen offset:384
    s_mov_b64 exec, -1
    ds_read_b128 v[184:187], v22 offset:0
    ds_read_b128 v[188:191], v22 offset:2304
    ds_read_b128 v[192:195], v23 offset:0
    ds_read_b128 v[196:199], v23 offset:2304
    ds_read_b128 v[200:203], v23 offset:4608
    ds_read_b128 v[204:207], v23 offset:6912
    ds_read_b128 v[208:211], v23 offset:9216
    ds_read_b128 v[212:215], v23 offset:11520
    ds_read_b128 v[216:219], v23 offset:13824
    ds_read_b128 v[220:223], v22 offset:64
    ds_read_b128 v[224:227], v22 offset:2368
    ds_read_b128 v[228:231], v23 offset:64
    ds_read_b128 v[232:235], v23 offset:2368
    ds_read_b128 v[236:239], v23 offset:4672
    ds_read_b128 v[240:243], v23 offset:6976
    ds_read_b128 v[244:247], v23 offset:9280
    ds_read_b128 v[248:251], v23 offset:11584
    ds_read_b128 v[252:255], v23 offset:13888
    s_waitcnt lgkmcnt(15)
    v_mfma_f32_16x16x32_bf16 v[32:35], v[184:187], v[192:195], v[32:35]
    v_mfma_f32_16x16x32_bf16 v[60:63], v[188:191], v[192:195], v[60:63]
    s_waitcnt lgkmcnt(14)
    v_mfma_f32_16x16x32_bf16 v[36:39], v[184:187], v[196:199], v[36:39]
    v_mfma_f32_16x16x32_bf16 v[64:67], v[188:191], v[196:199], v[64:67]
    s_waitcnt lgkmcnt(13)
    v_mfma_f32_16x16x32_bf16 v[40:43], v[184:187], v[200:203], v[40:43]
    v_mfma_f32_16x16x32_bf16 v[68:71], v[188:191], v[200:203], v[68:71]
    s_waitcnt lgkmcnt(12)
    v_mfma_f32_16x16x32_bf16 v[44:47], v[184:187], v[204:207], v[44:47]
    v_mfma_f32_16x16x32_bf16 v[72:75], v[188:191], v[204:207], v[72:75]
    s_waitcnt lgkmcnt(11)
    v_mfma_f32_16x16x32_bf16 v[48:51], v[184:187], v[208:211], v[48:51]
    v_mfma_f32_16x16x32_bf16 v[76:79], v[188:191], v[208:211], v[76:79]
    s_waitcnt lgkmcnt(10)
    v_mfma_f32_16x16x32_bf16 v[52:55], v[184:187], v[212:215], v[52:55]
    v_mfma_f32_16x16x32_bf16 v[80:83], v[188:191], v[212:215], v[80:83]
    s_waitcnt lgkmcnt(9)
    v_mfma_f32_16x16x32_bf16 v[56:59], v[184:187], v[216:219], v[56:59]
    v_mfma_f32_16x16x32_bf16 v[84:87], v[188:191], v[216:219], v[84:87]
    s_waitcnt lgkmcnt(6)
    v_mfma_f32_16x16x32_bf16 v[32:35], v[220:223], v[228:231], v[32:35]
    v_mfma_f32_16x16x32_bf16 v[60:63], v[224:227], v[228:231], v[60:63]
    s_waitcnt lgkmcnt(5)
    v_mfma_f32_16x16x32_bf16 v[36:39], v[220:223], v[232:235], v[36:39]
    v_mfma_f32_16x16x32_bf16 v[64:67], v[224:227], v[232:235], v[64:67]
    s_waitcnt lgkmcnt(4)
    v_mfma_f32_16x16x32_bf16 v[40:43], v[220:223], v[236:239], v[40:43]
    v_mfma_f32_16x16x32_bf16 v[68:71], v[224:227], v[236:239], v[68:71]
    s_waitcnt lgkmcnt(3)
    v_mfma_f32_16x16x32_bf16 v[44:47], v[220:223], v[240:243], v[44:47]
    v_mfma_f32_16x16x32_bf16 v[72:75], v[224:227], v[240:243], v[72:75]
    s_waitcnt lgkmcnt(2)
    v_mfma_f32_16x16x32_bf16 v[48:51], v[220:223], v[244:247], v[48:51]
    v_mfma_f32_16x16x32_bf16 v[76:79], v[224:227], v[244:247], v[76:79]
    s_waitcnt lgkmcnt(1)
    v_mfma_f32_16x16x32_bf16 v[52:55], v[220:223], v[248:251], v[52:55]
    v_mfma_f32_16x16x32_bf16 v[80:83], v[224:227], v[248:251], v[80:83]
    s_waitcnt lgkmcnt(0)
    v_mfma_f32_16x16x32_bf16 v[56:59], v[220:223], v[252:255], v[56:59]
    v_mfma_f32_16x16x32_bf16 v[84:87], v[224:227], v[252:255], v[84:87]
    s_waitcnt vmcnt(16)
    ds_write_b128 v21, v[120:123] offset:34560
    ds_write_b128 v21, v[124:127] offset:39168
    ds_write_b128 v21, v[128:131] offset:43776
    ds_write_b128 v21, v[132:135] offset:48384
    ds_write_b128 v25, v[136:139] offset:34560
    ds_write_b128 v25, v[140:143] offset:39168
    ds_write_b128 v25, v[144:147] offset:43776
    s_mov_b64 exec, s[22:23]
    ds_write_b128 v25, v[148:151] offset:48384
    s_mov_b64 exec, -1
    s_waitcnt lgkmcnt(0)
    s_barrier
    v_add_u32 v24, 0, v19
    buffer_load_dwordx4 v[120:123], v24, s[8:11], 0 offen offset:512
    v_add_u32 v24, 32768, v19
    buffer_load_dwordx4 v[124:127], v24, s[8:11], 0 offen offset:512
    v_add_u32 v24, 65536, v19
    buffer_load_dwordx4 v[128:131], v24, s[8:11], 0 offen offset:512
    v_add_u32 v24, 98304, v19
    buffer_load_dwordx4 v[132:135], v24, s[8:11], 0 offen offset:512
    v_add_u32 v24, 0, v20
    buffer_load_dwordx4 v[136:139], v24, s[8:11], 0 offen offset:512
    v_add_u32 v24, 32768, v20
    buffer_load_dwordx4 v[140:143], v24, s[8:11], 0 offen offset:512
    v_add_u32 v24, 65536, v20
    buffer_load_dwordx4 v[144:147], v24, s[8:11], 0 offen offset:512
    s_mov_b64 exec, s[22:23]
    v_add_u32 v24, 98304, v20
    buffer_load_dwordx4 v[148:151], v24, s[8:11], 0 offen offset:512
    s_mov_b64 exec, -1
    ds_read_b128 v[184:187], v22 offset:34560
    ds_read_b128 v[188:191], v22 offset:36864
    ds_read_b128 v[192:195], v23 offset:34560
    ds_read_b128 v[196:199], v23 offset:36864
    ds_read_b128 v[200:203], v23 offset:39168
    ds_read_b128 v[204:207], v23 offset:41472
    ds_read_b128 v[208:211], v23 offset:43776
    ds_read_b128 v[212:215], v23 offset:46080
    ds_read_b128 v[216:219], v23 offset:48384
    ds_read_b128 v[220:223], v22 offset:34624
    ds_read_b128 v[224:227], v22 offset:36928
    ds_read_b128 v[228:231], v23 offset:34624
    ds_read_b128 v[232:235], v23 offset:36928
    ds_read_b128 v[236:239], v23 offset:39232
    ds_read_b128 v[240:243], v23 offset:41536
    ds_read_b128 v[244:247], v23 offset:43840
    ds_read_b128 v[248:251], v23 offset:46144
    ds_read_b128 v[252:255], v23 offset:48448
    s_waitcnt lgkmcnt(15)
    v_mfma_f32_16x16x32_bf16 v[32:35], v[184:187], v[192:195], v[32:35]
    v_mfma_f32_16x16x32_bf16 v[60:63], v[188:191], v[192:195], v[60:63]
    s_waitcnt lgkmcnt(14)
    v_mfma_f32_16x16x32_bf16 v[36:39], v[184:187], v[196:199], v[36:39]
    v_mfma_f32_16x16x32_bf16 v[64:67], v[188:191], v[196:199], v[64:67]
    s_waitcnt lgkmcnt(13)
    v_mfma_f32_16x16x32_bf16 v[40:43], v[184:187], v[200:203], v[40:43]
    v_mfma_f32_16x16x32_bf16 v[68:71], v[188:191], v[200:203], v[68:71]
    s_waitcnt lgkmcnt(12)
    v_mfma_f32_16x16x32_bf16 v[44:47], v[184:187], v[204:207], v[44:47]
    v_mfma_f32_16x16x32_bf16 v[72:75], v[188:191], v[204:207], v[72:75]
    s_waitcnt lgkmcnt(11)
    v_mfma_f32_16x16x32_bf16 v[48:51], v[184:187], v[208:211], v[48:51]
    v_mfma_f32_16x16x32_bf16 v[76:79], v[188:191], v[208:211], v[76:79]
    s_waitcnt lgkmcnt(10)
    v_mfma_f32_16x16x32_bf16 v[52:55], v[184:187], v[212:215], v[52:55]
    v_mfma_f32_16x16x32_bf16 v[80:83], v[188:191], v[212:215], v[80:83]
    s_waitcnt lgkmcnt(9)
    v_mfma_f32_16x16x32_bf16 v[56:59], v[184:187], v[216:219], v[56:59]
    v_mfma_f32_16x16x32_bf16 v[84:87], v[188:191], v[216:219], v[84:87]
    s_waitcnt lgkmcnt(6)
    v_mfma_f32_16x16x32_bf16 v[32:35], v[220:223], v[228:231], v[32:35]
    v_mfma_f32_16x16x32_bf16 v[60:63], v[224:227], v[228:231], v[60:63]
    s_waitcnt lgkmcnt(5)
    v_mfma_f32_16x16x32_bf16 v[36:39], v[220:223], v[232:235], v[36:39]
    v_mfma_f32_16x16x32_bf16 v[64:67], v[224:227], v[232:235], v[64:67]
    s_waitcnt lgkmcnt(4)
    v_mfma_f32_16x16x32_bf16 v[40:43], v[220:223], v[236:239], v[40:43]
    v_mfma_f32_16x16x32_bf16 v[68:71], v[224:227], v[236:239], v[68:71]
    s_waitcnt lgkmcnt(3)
    v_mfma_f32_16x16x32_bf16 v[44:47], v[220:223], v[240:243], v[44:47]
    v_mfma_f32_16x16x32_bf16 v[72:75], v[224:227], v[240:243], v[72:75]
    s_waitcnt lgkmcnt(2)
    v_mfma_f32_16x16x32_bf16 v[48:51], v[220:223], v[244:247], v[48:51]
    v_mfma_f32_16x16x32_bf16 v[76:79], v[224:227], v[244:247], v[76:79]
    s_waitcnt lgkmcnt(1)
    v_mfma_f32_16x16x32_bf16 v[52:55], v[220:223], v[248:251], v[52:55]
    v_mfma_f32_16x16x32_bf16 v[80:83], v[224:227], v[248:251], v[80:83]
    s_waitcnt lgkmcnt(0)
    v_mfma_f32_16x16x32_bf16 v[56:59], v[220:223], v[252:255], v[56:59]
    v_mfma_f32_16x16x32_bf16 v[84:87], v[224:227], v[252:255], v[84:87]
    s_waitcnt vmcnt(16)
    ds_write_b128 v21, v[152:155] offset:0
    ds_write_b128 v21, v[156:159] offset:4608
    ds_write_b128 v21, v[160:163] offset:9216
    ds_write_b128 v21, v[164:167] offset:13824
    ds_write_b128 v25, v[168:171] offset:0
    ds_write_b128 v25, v[172:175] offset:4608
    ds_write_b128 v25, v[176:179] offset:9216
    s_mov_b64 exec, s[22:23]
    ds_write_b128 v25, v[180:183] offset:13824
    s_mov_b64 exec, -1
    s_waitcnt lgkmcnt(0)
    s_barrier
    v_add_u32 v24, 0, v19
    buffer_load_dwordx4 v[152:155], v24, s[8:11], 0 offen offset:640
    v_add_u32 v24, 32768, v19
    buffer_load_dwordx4 v[156:159], v24, s[8:11], 0 offen offset:640
    v_add_u32 v24, 65536, v19
    buffer_load_dwordx4 v[160:163], v24, s[8:11], 0 offen offset:640
    v_add_u32 v24, 98304, v19
    buffer_load_dwordx4 v[164:167], v24, s[8:11], 0 offen offset:640
    v_add_u32 v24, 0, v20
    buffer_load_dwordx4 v[168:171], v24, s[8:11], 0 offen offset:640
    v_add_u32 v24, 32768, v20
    buffer_load_dwordx4 v[172:175], v24, s[8:11], 0 offen offset:640
    v_add_u32 v24, 65536, v20
    buffer_load_dwordx4 v[176:179], v24, s[8:11], 0 offen offset:640
    s_mov_b64 exec, s[22:23]
    v_add_u32 v24, 98304, v20
    buffer_load_dwordx4 v[180:183], v24, s[8:11], 0 offen offset:640
    s_mov_b64 exec, -1
    ds_read_b128 v[184:187], v22 offset:0
    ds_read_b128 v[188:191], v22 offset:2304
    ds_read_b128 v[192:195], v23 offset:0
    ds_read_b128 v[196:199], v23 offset:2304
    ds_read_b128 v[200:203], v23 offset:4608
    ds_read_b128 v[204:207], v23 offset:6912
    ds_read_b128 v[208:211], v23 offset:9216
    ds_read_b128 v[212:215], v23 offset:11520
    ds_read_b128 v[216:219], v23 offset:13824
    ds_read_b128 v[220:223], v22 offset:64
    ds_read_b128 v[224:227], v22 offset:2368
    ds_read_b128 v[228:231], v23 offset:64
    ds_read_b128 v[232:235], v23 offset:2368
    ds_read_b128 v[236:239], v23 offset:4672
    ds_read_b128 v[240:243], v23 offset:6976
    ds_read_b128 v[244:247], v23 offset:9280
    ds_read_b128 v[248:251], v23 offset:11584
    ds_read_b128 v[252:255], v23 offset:13888
    s_waitcnt lgkmcnt(15)
    v_mfma_f32_16x16x32_bf16 v[32:35], v[184:187], v[192:195], v[32:35]
    v_mfma_f32_16x16x32_bf16 v[60:63], v[188:191], v[192:195], v[60:63]
    s_waitcnt lgkmcnt(14)
    v_mfma_f32_16x16x32_bf16 v[36:39], v[184:187], v[196:199], v[36:39]
    v_mfma_f32_16x16x32_bf16 v[64:67], v[188:191], v[196:199], v[64:67]
    s_waitcnt lgkmcnt(13)
    v_mfma_f32_16x16x32_bf16 v[40:43], v[184:187], v[200:203], v[40:43]
    v_mfma_f32_16x16x32_bf16 v[68:71], v[188:191], v[200:203], v[68:71]
    s_waitcnt lgkmcnt(12)
    v_mfma_f32_16x16x32_bf16 v[44:47], v[184:187], v[204:207], v[44:47]
    v_mfma_f32_16x16x32_bf16 v[72:75], v[188:191], v[204:207], v[72:75]
    s_waitcnt lgkmcnt(11)
    v_mfma_f32_16x16x32_bf16 v[48:51], v[184:187], v[208:211], v[48:51]
    v_mfma_f32_16x16x32_bf16 v[76:79], v[188:191], v[208:211], v[76:79]
    s_waitcnt lgkmcnt(10)
    v_mfma_f32_16x16x32_bf16 v[52:55], v[184:187], v[212:215], v[52:55]
    v_mfma_f32_16x16x32_bf16 v[80:83], v[188:191], v[212:215], v[80:83]
    s_waitcnt lgkmcnt(9)
    v_mfma_f32_16x16x32_bf16 v[56:59], v[184:187], v[216:219], v[56:59]
    v_mfma_f32_16x16x32_bf16 v[84:87], v[188:191], v[216:219], v[84:87]
    s_waitcnt lgkmcnt(6)
    v_mfma_f32_16x16x32_bf16 v[32:35], v[220:223], v[228:231], v[32:35]
    v_mfma_f32_16x16x32_bf16 v[60:63], v[224:227], v[228:231], v[60:63]
    s_waitcnt lgkmcnt(5)
    v_mfma_f32_16x16x32_bf16 v[36:39], v[220:223], v[232:235], v[36:39]
    v_mfma_f32_16x16x32_bf16 v[64:67], v[224:227], v[232:235], v[64:67]
    s_waitcnt lgkmcnt(4)
    v_mfma_f32_16x16x32_bf16 v[40:43], v[220:223], v[236:239], v[40:43]
    v_mfma_f32_16x16x32_bf16 v[68:71], v[224:227], v[236:239], v[68:71]
    s_waitcnt lgkmcnt(3)
    v_mfma_f32_16x16x32_bf16 v[44:47], v[220:223], v[240:243], v[44:47]
    v_mfma_f32_16x16x32_bf16 v[72:75], v[224:227], v[240:243], v[72:75]
    s_waitcnt lgkmcnt(2)
    v_mfma_f32_16x16x32_bf16 v[48:51], v[220:223], v[244:247], v[48:51]
    v_mfma_f32_16x16x32_bf16 v[76:79], v[224:227], v[244:247], v[76:79]
    s_waitcnt lgkmcnt(1)
    v_mfma_f32_16x16x32_bf16 v[52:55], v[220:223], v[248:251], v[52:55]
    v_mfma_f32_16x16x32_bf16 v[80:83], v[224:227], v[248:251], v[80:83]
    s_waitcnt lgkmcnt(0)
    v_mfma_f32_16x16x32_bf16 v[56:59], v[220:223], v[252:255], v[56:59]
    v_mfma_f32_16x16x32_bf16 v[84:87], v[224:227], v[252:255], v[84:87]
    s_waitcnt vmcnt(16)
    ds_write_b128 v21, v[88:91] offset:34560
    ds_write_b128 v21, v[92:95] offset:39168
    ds_write_b128 v21, v[96:99] offset:43776
    ds_write_b128 v21, v[100:103] offset:48384
    ds_write_b128 v25, v[104:107] offset:34560
    ds_write_b128 v25, v[108:111] offset:39168
    ds_write_b128 v25, v[112:115] offset:43776
    s_mov_b64 exec, s[22:23]
    ds_write_b128 v25, v[116:119] offset:48384
    s_mov_b64 exec, -1
    s_waitcnt lgkmcnt(0)
    s_barrier
    v_add_u32 v24, 0, v19
    buffer_load_dwordx4 v[88:91], v24, s[8:11], 0 offen offset:768
    v_add_u32 v24, 32768, v19
    buffer_load_dwordx4 v[92:95], v24, s[8:11], 0 offen offset:768
    v_add_u32 v24, 65536, v19
    buffer_load_dwordx4 v[96:99], v24, s[8:11], 0 offen offset:768
    v_add_u32 v24, 98304, v19
    buffer_load_dwordx4 v[100:103], v24, s[8:11], 0 offen offset:768
    v_add_u32 v24, 0, v20
    buffer_load_dwordx4 v[104:107], v24, s[8:11], 0 offen offset:768
    v_add_u32 v24, 32768, v20
    buffer_load_dwordx4 v[108:111], v24, s[8:11], 0 offen offset:768
    v_add_u32 v24, 65536, v20
    buffer_load_dwordx4 v[112:115], v24, s[8:11], 0 offen offset:768
    s_mov_b64 exec, s[22:23]
    v_add_u32 v24, 98304, v20
    buffer_load_dwordx4 v[116:119], v24, s[8:11], 0 offen offset:768
    s_mov_b64 exec, -1
    ds_read_b128 v[184:187], v22 offset:34560
    ds_read_b128 v[188:191], v22 offset:36864
    ds_read_b128 v[192:195], v23 offset:34560
    ds_read_b128 v[196:199], v23 offset:36864
    ds_read_b128 v[200:203], v23 offset:39168
    ds_read_b128 v[204:207], v23 offset:41472
    ds_read_b128 v[208:211], v23 offset:43776
    ds_read_b128 v[212:215], v23 offset:46080
    ds_read_b128 v[216:219], v23 offset:48384
    ds_read_b128 v[220:223], v22 offset:34624
    ds_read_b128 v[224:227], v22 offset:36928
    ds_read_b128 v[228:231], v23 offset:34624
    ds_read_b128 v[232:235], v23 offset:36928
    ds_read_b128 v[236:239], v23 offset:39232
    ds_read_b128 v[240:243], v23 offset:41536
    ds_read_b128 v[244:247], v23 offset:43840
    ds_read_b128 v[248:251], v23 offset:46144
    ds_read_b128 v[252:255], v23 offset:48448
    s_waitcnt lgkmcnt(15)
    v_mfma_f32_16x16x32_bf16 v[32:35], v[184:187], v[192:195], v[32:35]
    v_mfma_f32_16x16x32_bf16 v[60:63], v[188:191], v[192:195], v[60:63]
    s_waitcnt lgkmcnt(14)
    v_mfma_f32_16x16x32_bf16 v[36:39], v[184:187], v[196:199], v[36:39]
    v_mfma_f32_16x16x32_bf16 v[64:67], v[188:191], v[196:199], v[64:67]
    s_waitcnt lgkmcnt(13)
    v_mfma_f32_16x16x32_bf16 v[40:43], v[184:187], v[200:203], v[40:43]
    v_mfma_f32_16x16x32_bf16 v[68:71], v[188:191], v[200:203], v[68:71]
    s_waitcnt lgkmcnt(12)
    v_mfma_f32_16x16x32_bf16 v[44:47], v[184:187], v[204:207], v[44:47]
    v_mfma_f32_16x16x32_bf16 v[72:75], v[188:191], v[204:207], v[72:75]
    s_waitcnt lgkmcnt(11)
    v_mfma_f32_16x16x32_bf16 v[48:51], v[184:187], v[208:211], v[48:51]
    v_mfma_f32_16x16x32_bf16 v[76:79], v[188:191], v[208:211], v[76:79]
    s_waitcnt lgkmcnt(10)
    v_mfma_f32_16x16x32_bf16 v[52:55], v[184:187], v[212:215], v[52:55]
    v_mfma_f32_16x16x32_bf16 v[80:83], v[188:191], v[212:215], v[80:83]
    s_waitcnt lgkmcnt(9)
    v_mfma_f32_16x16x32_bf16 v[56:59], v[184:187], v[216:219], v[56:59]
    v_mfma_f32_16x16x32_bf16 v[84:87], v[188:191], v[216:219], v[84:87]
    s_waitcnt lgkmcnt(6)
    v_mfma_f32_16x16x32_bf16 v[32:35], v[220:223], v[228:231], v[32:35]
    v_mfma_f32_16x16x32_bf16 v[60:63], v[224:227], v[228:231], v[60:63]
    s_waitcnt lgkmcnt(5)
    v_mfma_f32_16x16x32_bf16 v[36:39], v[220:223], v[232:235], v[36:39]
    v_mfma_f32_16x16x32_bf16 v[64:67], v[224:227], v[232:235], v[64:67]
    s_waitcnt lgkmcnt(4)
    v_mfma_f32_16x16x32_bf16 v[40:43], v[220:223], v[236:239], v[40:43]
    v_mfma_f32_16x16x32_bf16 v[68:71], v[224:227], v[236:239], v[68:71]
    s_waitcnt lgkmcnt(3)
    v_mfma_f32_16x16x32_bf16 v[44:47], v[220:223], v[240:243], v[44:47]
    v_mfma_f32_16x16x32_bf16 v[72:75], v[224:227], v[240:243], v[72:75]
    s_waitcnt lgkmcnt(2)
    v_mfma_f32_16x16x32_bf16 v[48:51], v[220:223], v[244:247], v[48:51]
    v_mfma_f32_16x16x32_bf16 v[76:79], v[224:227], v[244:247], v[76:79]
    s_waitcnt lgkmcnt(1)
    v_mfma_f32_16x16x32_bf16 v[52:55], v[220:223], v[248:251], v[52:55]
    v_mfma_f32_16x16x32_bf16 v[80:83], v[224:227], v[248:251], v[80:83]
    s_waitcnt lgkmcnt(0)
    v_mfma_f32_16x16x32_bf16 v[56:59], v[220:223], v[252:255], v[56:59]
    v_mfma_f32_16x16x32_bf16 v[84:87], v[224:227], v[252:255], v[84:87]
    s_waitcnt vmcnt(16)
    ds_write_b128 v21, v[120:123] offset:0
    ds_write_b128 v21, v[124:127] offset:4608
    ds_write_b128 v21, v[128:131] offset:9216
    ds_write_b128 v21, v[132:135] offset:13824
    ds_write_b128 v25, v[136:139] offset:0
    ds_write_b128 v25, v[140:143] offset:4608
    ds_write_b128 v25, v[144:147] offset:9216
    s_mov_b64 exec, s[22:23]
    ds_write_b128 v25, v[148:151] offset:13824
    s_mov_b64 exec, -1
    s_waitcnt lgkmcnt(0)
    s_barrier
    v_add_u32 v24, 0, v19
    buffer_load_dwordx4 v[120:123], v24, s[8:11], 0 offen offset:896
    v_add_u32 v24, 32768, v19
    buffer_load_dwordx4 v[124:127], v24, s[8:11], 0 offen offset:896
    v_add_u32 v24, 65536, v19
    buffer_load_dwordx4 v[128:131], v24, s[8:11], 0 offen offset:896
    v_add_u32 v24, 98304, v19
    buffer_load_dwordx4 v[132:135], v24, s[8:11], 0 offen offset:896
    v_add_u32 v24, 0, v20
    buffer_load_dwordx4 v[136:139], v24, s[8:11], 0 offen offset:896
    v_add_u32 v24, 32768, v20
    buffer_load_dwordx4 v[140:143], v24, s[8:11], 0 offen offset:896
    v_add_u32 v24, 65536, v20
    buffer_load_dwordx4 v[144:147], v24, s[8:11], 0 offen offset:896
    s_mov_b64 exec, s[22:23]
    v_add_u32 v24, 98304, v20
    buffer_load_dwordx4 v[148:151], v24, s[8:11], 0 offen offset:896
    s_mov_b64 exec, -1
    ds_read_b128 v[184:187], v22 offset:0
    ds_read_b128 v[188:191], v22 offset:2304
    ds_read_b128 v[192:195], v23 offset:0
    ds_read_b128 v[196:199], v23 offset:2304
    ds_read_b128 v[200:203], v23 offset:4608
    ds_read_b128 v[204:207], v23 offset:6912
    ds_read_b128 v[208:211], v23 offset:9216
    ds_read_b128 v[212:215], v23 offset:11520
    ds_read_b128 v[216:219], v23 offset:13824
    ds_read_b128 v[220:223], v22 offset:64
    ds_read_b128 v[224:227], v22 offset:2368
    ds_read_b128 v[228:231], v23 offset:64
    ds_read_b128 v[232:235], v23 offset:2368
    ds_read_b128 v[236:239], v23 offset:4672
    ds_read_b128 v[240:243], v23 offset:6976
    ds_read_b128 v[244:247], v23 offset:9280
    ds_read_b128 v[248:251], v23 offset:11584
    ds_read_b128 v[252:255], v23 offset:13888
    s_waitcnt lgkmcnt(15)
    v_mfma_f32_16x16x32_bf16 v[32:35], v[184:187], v[192:195], v[32:35]
    v_mfma_f32_16x16x32_bf16 v[60:63], v[188:191], v[192:195], v[60:63]
    s_waitcnt lgkmcnt(14)
    v_mfma_f32_16x16x32_bf16 v[36:39], v[184:187], v[196:199], v[36:39]
    v_mfma_f32_16x16x32_bf16 v[64:67], v[188:191], v[196:199], v[64:67]
    s_waitcnt lgkmcnt(13)
    v_mfma_f32_16x16x32_bf16 v[40:43], v[184:187], v[200:203], v[40:43]
    v_mfma_f32_16x16x32_bf16 v[68:71], v[188:191], v[200:203], v[68:71]
    s_waitcnt lgkmcnt(12)
    v_mfma_f32_16x16x32_bf16 v[44:47], v[184:187], v[204:207], v[44:47]
    v_mfma_f32_16x16x32_bf16 v[72:75], v[188:191], v[204:207], v[72:75]
    s_waitcnt lgkmcnt(11)
    v_mfma_f32_16x16x32_bf16 v[48:51], v[184:187], v[208:211], v[48:51]
    v_mfma_f32_16x16x32_bf16 v[76:79], v[188:191], v[208:211], v[76:79]
    s_waitcnt lgkmcnt(10)
    v_mfma_f32_16x16x32_bf16 v[52:55], v[184:187], v[212:215], v[52:55]
    v_mfma_f32_16x16x32_bf16 v[80:83], v[188:191], v[212:215], v[80:83]
    s_waitcnt lgkmcnt(9)
    v_mfma_f32_16x16x32_bf16 v[56:59], v[184:187], v[216:219], v[56:59]
    v_mfma_f32_16x16x32_bf16 v[84:87], v[188:191], v[216:219], v[84:87]
    s_waitcnt lgkmcnt(6)
    v_mfma_f32_16x16x32_bf16 v[32:35], v[220:223], v[228:231], v[32:35]
    v_mfma_f32_16x16x32_bf16 v[60:63], v[224:227], v[228:231], v[60:63]
    s_waitcnt lgkmcnt(5)
    v_mfma_f32_16x16x32_bf16 v[36:39], v[220:223], v[232:235], v[36:39]
    v_mfma_f32_16x16x32_bf16 v[64:67], v[224:227], v[232:235], v[64:67]
    s_waitcnt lgkmcnt(4)
    v_mfma_f32_16x16x32_bf16 v[40:43], v[220:223], v[236:239], v[40:43]
    v_mfma_f32_16x16x32_bf16 v[68:71], v[224:227], v[236:239], v[68:71]
    s_waitcnt lgkmcnt(3)
    v_mfma_f32_16x16x32_bf16 v[44:47], v[220:223], v[240:243], v[44:47]
    v_mfma_f32_16x16x32_bf16 v[72:75], v[224:227], v[240:243], v[72:75]
    s_waitcnt lgkmcnt(2)
    v_mfma_f32_16x16x32_bf16 v[48:51], v[220:223], v[244:247], v[48:51]
    v_mfma_f32_16x16x32_bf16 v[76:79], v[224:227], v[244:247], v[76:79]
    s_waitcnt lgkmcnt(1)
    v_mfma_f32_16x16x32_bf16 v[52:55], v[220:223], v[248:251], v[52:55]
    v_mfma_f32_16x16x32_bf16 v[80:83], v[224:227], v[248:251], v[80:83]
    s_waitcnt lgkmcnt(0)
    v_mfma_f32_16x16x32_bf16 v[56:59], v[220:223], v[252:255], v[56:59]
    v_mfma_f32_16x16x32_bf16 v[84:87], v[224:227], v[252:255], v[84:87]
    s_waitcnt vmcnt(16)
    ds_write_b128 v21, v[152:155] offset:34560
    ds_write_b128 v21, v[156:159] offset:39168
    ds_write_b128 v21, v[160:163] offset:43776
    ds_write_b128 v21, v[164:167] offset:48384
    ds_write_b128 v25, v[168:171] offset:34560
    ds_write_b128 v25, v[172:175] offset:39168
    ds_write_b128 v25, v[176:179] offset:43776
    s_mov_b64 exec, s[22:23]
    ds_write_b128 v25, v[180:183] offset:48384
    s_mov_b64 exec, -1
    s_waitcnt lgkmcnt(0)
    s_barrier
    ds_read_b128 v[184:187], v22 offset:34560
    ds_read_b128 v[188:191], v22 offset:36864
    ds_read_b128 v[192:195], v23 offset:34560
    ds_read_b128 v[196:199], v23 offset:36864
    ds_read_b128 v[200:203], v23 offset:39168
    ds_read_b128 v[204:207], v23 offset:41472
    ds_read_b128 v[208:211], v23 offset:43776
    ds_read_b128 v[212:215], v23 offset:46080
    ds_read_b128 v[216:219], v23 offset:48384
    ds_read_b128 v[220:223], v22 offset:34624
    ds_read_b128 v[224:227], v22 offset:36928
    ds_read_b128 v[228:231], v23 offset:34624
    ds_read_b128 v[232:235], v23 offset:36928
    ds_read_b128 v[236:239], v23 offset:39232
    ds_read_b128 v[240:243], v23 offset:41536
    ds_read_b128 v[244:247], v23 offset:43840
    ds_read_b128 v[248:251], v23 offset:46144
    ds_read_b128 v[252:255], v23 offset:48448
    s_waitcnt lgkmcnt(15)
    v_mfma_f32_16x16x32_bf16 v[32:35], v[184:187], v[192:195], v[32:35]
    v_mfma_f32_16x16x32_bf16 v[60:63], v[188:191], v[192:195], v[60:63]
    s_waitcnt lgkmcnt(14)
    v_mfma_f32_16x16x32_bf16 v[36:39], v[184:187], v[196:199], v[36:39]
    v_mfma_f32_16x16x32_bf16 v[64:67], v[188:191], v[196:199], v[64:67]
    s_waitcnt lgkmcnt(13)
    v_mfma_f32_16x16x32_bf16 v[40:43], v[184:187], v[200:203], v[40:43]
    v_mfma_f32_16x16x32_bf16 v[68:71], v[188:191], v[200:203], v[68:71]
    s_waitcnt lgkmcnt(12)
    v_mfma_f32_16x16x32_bf16 v[44:47], v[184:187], v[204:207], v[44:47]
    v_mfma_f32_16x16x32_bf16 v[72:75], v[188:191], v[204:207], v[72:75]
    s_waitcnt lgkmcnt(11)
    v_mfma_f32_16x16x32_bf16 v[48:51], v[184:187], v[208:211], v[48:51]
    v_mfma_f32_16x16x32_bf16 v[76:79], v[188:191], v[208:211], v[76:79]
    s_waitcnt lgkmcnt(10)
    v_mfma_f32_16x16x32_bf16 v[52:55], v[184:187], v[212:215], v[52:55]
    v_mfma_f32_16x16x32_bf16 v[80:83], v[188:191], v[212:215], v[80:83]
    s_waitcnt lgkmcnt(9)
    v_mfma_f32_16x16x32_bf16 v[56:59], v[184:187], v[216:219], v[56:59]
    v_mfma_f32_16x16x32_bf16 v[84:87], v[188:191], v[216:219], v[84:87]
    s_waitcnt lgkmcnt(6)
    v_mfma_f32_16x16x32_bf16 v[32:35], v[220:223], v[228:231], v[32:35]
    v_mfma_f32_16x16x32_bf16 v[60:63], v[224:227], v[228:231], v[60:63]
    s_waitcnt lgkmcnt(5)
    v_mfma_f32_16x16x32_bf16 v[36:39], v[220:223], v[232:235], v[36:39]
    v_mfma_f32_16x16x32_bf16 v[64:67], v[224:227], v[232:235], v[64:67]
    s_waitcnt lgkmcnt(4)
    v_mfma_f32_16x16x32_bf16 v[40:43], v[220:223], v[236:239], v[40:43]
    v_mfma_f32_16x16x32_bf16 v[68:71], v[224:227], v[236:239], v[68:71]
    s_waitcnt lgkmcnt(3)
    v_mfma_f32_16x16x32_bf16 v[44:47], v[220:223], v[240:243], v[44:47]
    v_mfma_f32_16x16x32_bf16 v[72:75], v[224:227], v[240:243], v[72:75]
    s_waitcnt lgkmcnt(2)
    v_mfma_f32_16x16x32_bf16 v[48:51], v[220:223], v[244:247], v[48:51]
    v_mfma_f32_16x16x32_bf16 v[76:79], v[224:227], v[244:247], v[76:79]
    s_waitcnt lgkmcnt(1)
    v_mfma_f32_16x16x32_bf16 v[52:55], v[220:223], v[248:251], v[52:55]
    v_mfma_f32_16x16x32_bf16 v[80:83], v[224:227], v[248:251], v[80:83]
    s_waitcnt lgkmcnt(0)
    v_mfma_f32_16x16x32_bf16 v[56:59], v[220:223], v[252:255], v[56:59]
    v_mfma_f32_16x16x32_bf16 v[84:87], v[224:227], v[252:255], v[84:87]
    s_waitcnt vmcnt(8)
    ds_write_b128 v21, v[88:91] offset:0
    ds_write_b128 v21, v[92:95] offset:4608
    ds_write_b128 v21, v[96:99] offset:9216
    ds_write_b128 v21, v[100:103] offset:13824
    ds_write_b128 v25, v[104:107] offset:0
    ds_write_b128 v25, v[108:111] offset:4608
    ds_write_b128 v25, v[112:115] offset:9216
    s_mov_b64 exec, s[22:23]
    ds_write_b128 v25, v[116:119] offset:13824
    s_mov_b64 exec, -1
    s_waitcnt lgkmcnt(0)
    s_barrier
    ds_read_b128 v[184:187], v22 offset:0
    ds_read_b128 v[188:191], v22 offset:2304
    ds_read_b128 v[192:195], v23 offset:0
    ds_read_b128 v[196:199], v23 offset:2304
    ds_read_b128 v[200:203], v23 offset:4608
    ds_read_b128 v[204:207], v23 offset:6912
    ds_read_b128 v[208:211], v23 offset:9216
    ds_read_b128 v[212:215], v23 offset:11520
    ds_read_b128 v[216:219], v23 offset:13824
    ds_read_b128 v[220:223], v22 offset:64
    ds_read_b128 v[224:227], v22 offset:2368
    ds_read_b128 v[228:231], v23 offset:64
    ds_read_b128 v[232:235], v23 offset:2368
    ds_read_b128 v[236:239], v23 offset:4672
    ds_read_b128 v[240:243], v23 offset:6976
    ds_read_b128 v[244:247], v23 offset:9280
    ds_read_b128 v[248:251], v23 offset:11584
    ds_read_b128 v[252:255], v23 offset:13888
    s_waitcnt lgkmcnt(15)
    v_mfma_f32_16x16x32_bf16 v[32:35], v[184:187], v[192:195], v[32:35]
    v_mfma_f32_16x16x32_bf16 v[60:63], v[188:191], v[192:195], v[60:63]
    s_waitcnt lgkmcnt(14)
    v_mfma_f32_16x16x32_bf16 v[36:39], v[184:187], v[196:199], v[36:39]
    v_mfma_f32_16x16x32_bf16 v[64:67], v[188:191], v[196:199], v[64:67]
    s_waitcnt lgkmcnt(13)
    v_mfma_f32_16x16x32_bf16 v[40:43], v[184:187], v[200:203], v[40:43]
    v_mfma_f32_16x16x32_bf16 v[68:71], v[188:191], v[200:203], v[68:71]
    s_waitcnt lgkmcnt(12)
    v_mfma_f32_16x16x32_bf16 v[44:47], v[184:187], v[204:207], v[44:47]
    v_mfma_f32_16x16x32_bf16 v[72:75], v[188:191], v[204:207], v[72:75]
    s_waitcnt lgkmcnt(11)
    v_mfma_f32_16x16x32_bf16 v[48:51], v[184:187], v[208:211], v[48:51]
    v_mfma_f32_16x16x32_bf16 v[76:79], v[188:191], v[208:211], v[76:79]
    s_waitcnt lgkmcnt(10)
    v_mfma_f32_16x16x32_bf16 v[52:55], v[184:187], v[212:215], v[52:55]
    v_mfma_f32_16x16x32_bf16 v[80:83], v[188:191], v[212:215], v[80:83]
    s_waitcnt lgkmcnt(9)
    v_mfma_f32_16x16x32_bf16 v[56:59], v[184:187], v[216:219], v[56:59]
    v_mfma_f32_16x16x32_bf16 v[84:87], v[188:191], v[216:219], v[84:87]
    s_waitcnt lgkmcnt(6)
    v_mfma_f32_16x16x32_bf16 v[32:35], v[220:223], v[228:231], v[32:35]
    v_mfma_f32_16x16x32_bf16 v[60:63], v[224:227], v[228:231], v[60:63]
    s_waitcnt lgkmcnt(5)
    v_mfma_f32_16x16x32_bf16 v[36:39], v[220:223], v[232:235], v[36:39]
    v_mfma_f32_16x16x32_bf16 v[64:67], v[224:227], v[232:235], v[64:67]
    s_waitcnt lgkmcnt(4)
    v_mfma_f32_16x16x32_bf16 v[40:43], v[220:223], v[236:239], v[40:43]
    v_mfma_f32_16x16x32_bf16 v[68:71], v[224:227], v[236:239], v[68:71]
    s_waitcnt lgkmcnt(3)
    v_mfma_f32_16x16x32_bf16 v[44:47], v[220:223], v[240:243], v[44:47]
    v_mfma_f32_16x16x32_bf16 v[72:75], v[224:227], v[240:243], v[72:75]
    s_waitcnt lgkmcnt(2)
    v_mfma_f32_16x16x32_bf16 v[48:51], v[220:223], v[244:247], v[48:51]
    v_mfma_f32_16x16x32_bf16 v[76:79], v[224:227], v[244:247], v[76:79]
    s_waitcnt lgkmcnt(1)
    v_mfma_f32_16x16x32_bf16 v[52:55], v[220:223], v[248:251], v[52:55]
    v_mfma_f32_16x16x32_bf16 v[80:83], v[224:227], v[248:251], v[80:83]
    s_waitcnt lgkmcnt(0)
    v_mfma_f32_16x16x32_bf16 v[56:59], v[220:223], v[252:255], v[56:59]
    v_mfma_f32_16x16x32_bf16 v[84:87], v[224:227], v[252:255], v[84:87]
    s_waitcnt vmcnt(0)
    ds_write_b128 v21, v[120:123] offset:34560
    ds_write_b128 v21, v[124:127] offset:39168
    ds_write_b128 v21, v[128:131] offset:43776
    ds_write_b128 v21, v[132:135] offset:48384
    ds_write_b128 v25, v[136:139] offset:34560
    ds_write_b128 v25, v[140:143] offset:39168
    ds_write_b128 v25, v[144:147] offset:43776
    s_mov_b64 exec, s[22:23]
    ds_write_b128 v25, v[148:151] offset:48384
    s_mov_b64 exec, -1
    s_waitcnt lgkmcnt(0)
    s_barrier
    ds_read_b128 v[184:187], v22 offset:34560
    ds_read_b128 v[188:191], v22 offset:36864
    ds_read_b128 v[192:195], v23 offset:34560
    ds_read_b128 v[196:199], v23 offset:36864
    ds_read_b128 v[200:203], v23 offset:39168
    ds_read_b128 v[204:207], v23 offset:41472
    ds_read_b128 v[208:211], v23 offset:43776
    ds_read_b128 v[212:215], v23 offset:46080
    ds_read_b128 v[216:219], v23 offset:48384
    ds_read_b128 v[220:223], v22 offset:34624
    ds_read_b128 v[224:227], v22 offset:36928
    ds_read_b128 v[228:231], v23 offset:34624
    ds_read_b128 v[232:235], v23 offset:36928
    ds_read_b128 v[236:239], v23 offset:39232
    ds_read_b128 v[240:243], v23 offset:41536
    ds_read_b128 v[244:247], v23 offset:43840
    ds_read_b128 v[248:251], v23 offset:46144
    ds_read_b128 v[252:255], v23 offset:48448
    s_waitcnt lgkmcnt(15)
    v_mfma_f32_16x16x32_bf16 v[32:35], v[184:187], v[192:195], v[32:35]
    v_mfma_f32_16x16x32_bf16 v[60:63], v[188:191], v[192:195], v[60:63]
    s_waitcnt lgkmcnt(14)
    v_mfma_f32_16x16x32_bf16 v[36:39], v[184:187], v[196:199], v[36:39]
    v_mfma_f32_16x16x32_bf16 v[64:67], v[188:191], v[196:199], v[64:67]
    s_waitcnt lgkmcnt(13)
    v_mfma_f32_16x16x32_bf16 v[40:43], v[184:187], v[200:203], v[40:43]
    v_mfma_f32_16x16x32_bf16 v[68:71], v[188:191], v[200:203], v[68:71]
    s_waitcnt lgkmcnt(12)
    v_mfma_f32_16x16x32_bf16 v[44:47], v[184:187], v[204:207], v[44:47]
    v_mfma_f32_16x16x32_bf16 v[72:75], v[188:191], v[204:207], v[72:75]
    s_waitcnt lgkmcnt(11)
    v_mfma_f32_16x16x32_bf16 v[48:51], v[184:187], v[208:211], v[48:51]
    v_mfma_f32_16x16x32_bf16 v[76:79], v[188:191], v[208:211], v[76:79]
    s_waitcnt lgkmcnt(10)
    v_mfma_f32_16x16x32_bf16 v[52:55], v[184:187], v[212:215], v[52:55]
    v_mfma_f32_16x16x32_bf16 v[80:83], v[188:191], v[212:215], v[80:83]
    s_waitcnt lgkmcnt(9)
    v_mfma_f32_16x16x32_bf16 v[56:59], v[184:187], v[216:219], v[56:59]
    v_mfma_f32_16x16x32_bf16 v[84:87], v[188:191], v[216:219], v[84:87]
    s_waitcnt lgkmcnt(6)
    v_mfma_f32_16x16x32_bf16 v[32:35], v[220:223], v[228:231], v[32:35]
    v_mfma_f32_16x16x32_bf16 v[60:63], v[224:227], v[228:231], v[60:63]
    s_waitcnt lgkmcnt(5)
    v_mfma_f32_16x16x32_bf16 v[36:39], v[220:223], v[232:235], v[36:39]
    v_mfma_f32_16x16x32_bf16 v[64:67], v[224:227], v[232:235], v[64:67]
    s_waitcnt lgkmcnt(4)
    v_mfma_f32_16x16x32_bf16 v[40:43], v[220:223], v[236:239], v[40:43]
    v_mfma_f32_16x16x32_bf16 v[68:71], v[224:227], v[236:239], v[68:71]
    s_waitcnt lgkmcnt(3)
    v_mfma_f32_16x16x32_bf16 v[44:47], v[220:223], v[240:243], v[44:47]
    v_mfma_f32_16x16x32_bf16 v[72:75], v[224:227], v[240:243], v[72:75]
    s_waitcnt lgkmcnt(2)
    v_mfma_f32_16x16x32_bf16 v[48:51], v[220:223], v[244:247], v[48:51]
    v_mfma_f32_16x16x32_bf16 v[76:79], v[224:227], v[244:247], v[76:79]
    s_waitcnt lgkmcnt(1)
    v_mfma_f32_16x16x32_bf16 v[52:55], v[220:223], v[248:251], v[52:55]
    v_mfma_f32_16x16x32_bf16 v[80:83], v[224:227], v[248:251], v[80:83]
    s_waitcnt lgkmcnt(0)
    v_mfma_f32_16x16x32_bf16 v[56:59], v[220:223], v[252:255], v[56:59]
    v_mfma_f32_16x16x32_bf16 v[84:87], v[224:227], v[252:255], v[84:87]
    s_nop 15
    s_barrier
    v_lshlrev_b32 v6, 5, v3
    v_lshl_add_u32 v6, v2, 2, v6
    v_mul_u32_u24 v6, 240, v6
    v_lshl_add_u32 v6, v1, 1, v6

    v_cvt_pk_bf16_f32 v8, v32, v32
    v_lshlrev_b32 v8, 16, v8
    v_mul_f32 v9, 0xbfb8aa3b, v8
    v_exp_f32 v9, v9
    s_nop 0
    v_add_f32 v9, 1.0, v9
    v_rcp_f32 v9, v9
    s_nop 0
    v_mul_f32 v8, v8, v9
    v_cvt_pk_bf16_f32 v8, v8, v8
    ds_write_b16 v6, v8 offset:0

    v_cvt_pk_bf16_f32 v8, v33, v33
    v_lshlrev_b32 v8, 16, v8
    v_mul_f32 v9, 0xbfb8aa3b, v8
    v_exp_f32 v9, v9
    s_nop 0
    v_add_f32 v9, 1.0, v9
    v_rcp_f32 v9, v9
    s_nop 0
    v_mul_f32 v8, v8, v9
    v_cvt_pk_bf16_f32 v8, v8, v8
    ds_write_b16 v6, v8 offset:240

    v_cvt_pk_bf16_f32 v8, v34, v34
    v_lshlrev_b32 v8, 16, v8
    v_mul_f32 v9, 0xbfb8aa3b, v8
    v_exp_f32 v9, v9
    s_nop 0
    v_add_f32 v9, 1.0, v9
    v_rcp_f32 v9, v9
    s_nop 0
    v_mul_f32 v8, v8, v9
    v_cvt_pk_bf16_f32 v8, v8, v8
    ds_write_b16 v6, v8 offset:480

    v_cvt_pk_bf16_f32 v8, v35, v35
    v_lshlrev_b32 v8, 16, v8
    v_mul_f32 v9, 0xbfb8aa3b, v8
    v_exp_f32 v9, v9
    s_nop 0
    v_add_f32 v9, 1.0, v9
    v_rcp_f32 v9, v9
    s_nop 0
    v_mul_f32 v8, v8, v9
    v_cvt_pk_bf16_f32 v8, v8, v8
    ds_write_b16 v6, v8 offset:720

    v_cvt_pk_bf16_f32 v8, v36, v36
    v_lshlrev_b32 v8, 16, v8
    v_mul_f32 v9, 0xbfb8aa3b, v8
    v_exp_f32 v9, v9
    s_nop 0
    v_add_f32 v9, 1.0, v9
    v_rcp_f32 v9, v9
    s_nop 0
    v_mul_f32 v8, v8, v9
    v_cvt_pk_bf16_f32 v8, v8, v8
    ds_write_b16 v6, v8 offset:32

    v_cvt_pk_bf16_f32 v8, v37, v37
    v_lshlrev_b32 v8, 16, v8
    v_mul_f32 v9, 0xbfb8aa3b, v8
    v_exp_f32 v9, v9
    s_nop 0
    v_add_f32 v9, 1.0, v9
    v_rcp_f32 v9, v9
    s_nop 0
    v_mul_f32 v8, v8, v9
    v_cvt_pk_bf16_f32 v8, v8, v8
    ds_write_b16 v6, v8 offset:272

    v_cvt_pk_bf16_f32 v8, v38, v38
    v_lshlrev_b32 v8, 16, v8
    v_mul_f32 v9, 0xbfb8aa3b, v8
    v_exp_f32 v9, v9
    s_nop 0
    v_add_f32 v9, 1.0, v9
    v_rcp_f32 v9, v9
    s_nop 0
    v_mul_f32 v8, v8, v9
    v_cvt_pk_bf16_f32 v8, v8, v8
    ds_write_b16 v6, v8 offset:512

    v_cvt_pk_bf16_f32 v8, v39, v39
    v_lshlrev_b32 v8, 16, v8
    v_mul_f32 v9, 0xbfb8aa3b, v8
    v_exp_f32 v9, v9
    s_nop 0
    v_add_f32 v9, 1.0, v9
    v_rcp_f32 v9, v9
    s_nop 0
    v_mul_f32 v8, v8, v9
    v_cvt_pk_bf16_f32 v8, v8, v8
    ds_write_b16 v6, v8 offset:752

    v_cvt_pk_bf16_f32 v8, v40, v40
    v_lshlrev_b32 v8, 16, v8
    v_mul_f32 v9, 0xbfb8aa3b, v8
    v_exp_f32 v9, v9
    s_nop 0
    v_add_f32 v9, 1.0, v9
    v_rcp_f32 v9, v9
    s_nop 0
    v_mul_f32 v8, v8, v9
    v_cvt_pk_bf16_f32 v8, v8, v8
    ds_write_b16 v6, v8 offset:64

    v_cvt_pk_bf16_f32 v8, v41, v41
    v_lshlrev_b32 v8, 16, v8
    v_mul_f32 v9, 0xbfb8aa3b, v8
    v_exp_f32 v9, v9
    s_nop 0
    v_add_f32 v9, 1.0, v9
    v_rcp_f32 v9, v9
    s_nop 0
    v_mul_f32 v8, v8, v9
    v_cvt_pk_bf16_f32 v8, v8, v8
    ds_write_b16 v6, v8 offset:304

    v_cvt_pk_bf16_f32 v8, v42, v42
    v_lshlrev_b32 v8, 16, v8
    v_mul_f32 v9, 0xbfb8aa3b, v8
    v_exp_f32 v9, v9
    s_nop 0
    v_add_f32 v9, 1.0, v9
    v_rcp_f32 v9, v9
    s_nop 0
    v_mul_f32 v8, v8, v9
    v_cvt_pk_bf16_f32 v8, v8, v8
    ds_write_b16 v6, v8 offset:544

    v_cvt_pk_bf16_f32 v8, v43, v43
    v_lshlrev_b32 v8, 16, v8
    v_mul_f32 v9, 0xbfb8aa3b, v8
    v_exp_f32 v9, v9
    s_nop 0
    v_add_f32 v9, 1.0, v9
    v_rcp_f32 v9, v9
    s_nop 0
    v_mul_f32 v8, v8, v9
    v_cvt_pk_bf16_f32 v8, v8, v8
    ds_write_b16 v6, v8 offset:784

    v_cvt_pk_bf16_f32 v8, v44, v44
    v_lshlrev_b32 v8, 16, v8
    v_mul_f32 v9, 0xbfb8aa3b, v8
    v_exp_f32 v9, v9
    s_nop 0
    v_add_f32 v9, 1.0, v9
    v_rcp_f32 v9, v9
    s_nop 0
    v_mul_f32 v8, v8, v9
    v_cvt_pk_bf16_f32 v8, v8, v8
    ds_write_b16 v6, v8 offset:96

    v_cvt_pk_bf16_f32 v8, v45, v45
    v_lshlrev_b32 v8, 16, v8
    v_mul_f32 v9, 0xbfb8aa3b, v8
    v_exp_f32 v9, v9
    s_nop 0
    v_add_f32 v9, 1.0, v9
    v_rcp_f32 v9, v9
    s_nop 0
    v_mul_f32 v8, v8, v9
    v_cvt_pk_bf16_f32 v8, v8, v8
    ds_write_b16 v6, v8 offset:336

    v_cvt_pk_bf16_f32 v8, v46, v46
    v_lshlrev_b32 v8, 16, v8
    v_mul_f32 v9, 0xbfb8aa3b, v8
    v_exp_f32 v9, v9
    s_nop 0
    v_add_f32 v9, 1.0, v9
    v_rcp_f32 v9, v9
    s_nop 0
    v_mul_f32 v8, v8, v9
    v_cvt_pk_bf16_f32 v8, v8, v8
    ds_write_b16 v6, v8 offset:576

    v_cvt_pk_bf16_f32 v8, v47, v47
    v_lshlrev_b32 v8, 16, v8
    v_mul_f32 v9, 0xbfb8aa3b, v8
    v_exp_f32 v9, v9
    s_nop 0
    v_add_f32 v9, 1.0, v9
    v_rcp_f32 v9, v9
    s_nop 0
    v_mul_f32 v8, v8, v9
    v_cvt_pk_bf16_f32 v8, v8, v8
    ds_write_b16 v6, v8 offset:816

    v_cvt_pk_bf16_f32 v8, v48, v48
    v_lshlrev_b32 v8, 16, v8
    v_mul_f32 v9, 0xbfb8aa3b, v8
    v_exp_f32 v9, v9
    s_nop 0
    v_add_f32 v9, 1.0, v9
    v_rcp_f32 v9, v9
    s_nop 0
    v_mul_f32 v8, v8, v9
    v_cvt_pk_bf16_f32 v8, v8, v8
    ds_write_b16 v6, v8 offset:128

    v_cvt_pk_bf16_f32 v8, v49, v49
    v_lshlrev_b32 v8, 16, v8
    v_mul_f32 v9, 0xbfb8aa3b, v8
    v_exp_f32 v9, v9
    s_nop 0
    v_add_f32 v9, 1.0, v9
    v_rcp_f32 v9, v9
    s_nop 0
    v_mul_f32 v8, v8, v9
    v_cvt_pk_bf16_f32 v8, v8, v8
    ds_write_b16 v6, v8 offset:368

    v_cvt_pk_bf16_f32 v8, v50, v50
    v_lshlrev_b32 v8, 16, v8
    v_mul_f32 v9, 0xbfb8aa3b, v8
    v_exp_f32 v9, v9
    s_nop 0
    v_add_f32 v9, 1.0, v9
    v_rcp_f32 v9, v9
    s_nop 0
    v_mul_f32 v8, v8, v9
    v_cvt_pk_bf16_f32 v8, v8, v8
    ds_write_b16 v6, v8 offset:608

    v_cvt_pk_bf16_f32 v8, v51, v51
    v_lshlrev_b32 v8, 16, v8
    v_mul_f32 v9, 0xbfb8aa3b, v8
    v_exp_f32 v9, v9
    s_nop 0
    v_add_f32 v9, 1.0, v9
    v_rcp_f32 v9, v9
    s_nop 0
    v_mul_f32 v8, v8, v9
    v_cvt_pk_bf16_f32 v8, v8, v8
    ds_write_b16 v6, v8 offset:848

    v_cvt_pk_bf16_f32 v8, v52, v52
    v_lshlrev_b32 v8, 16, v8
    v_mul_f32 v9, 0xbfb8aa3b, v8
    v_exp_f32 v9, v9
    s_nop 0
    v_add_f32 v9, 1.0, v9
    v_rcp_f32 v9, v9
    s_nop 0
    v_mul_f32 v8, v8, v9
    v_cvt_pk_bf16_f32 v8, v8, v8
    ds_write_b16 v6, v8 offset:160

    v_cvt_pk_bf16_f32 v8, v53, v53
    v_lshlrev_b32 v8, 16, v8
    v_mul_f32 v9, 0xbfb8aa3b, v8
    v_exp_f32 v9, v9
    s_nop 0
    v_add_f32 v9, 1.0, v9
    v_rcp_f32 v9, v9
    s_nop 0
    v_mul_f32 v8, v8, v9
    v_cvt_pk_bf16_f32 v8, v8, v8
    ds_write_b16 v6, v8 offset:400

    v_cvt_pk_bf16_f32 v8, v54, v54
    v_lshlrev_b32 v8, 16, v8
    v_mul_f32 v9, 0xbfb8aa3b, v8
    v_exp_f32 v9, v9
    s_nop 0
    v_add_f32 v9, 1.0, v9
    v_rcp_f32 v9, v9
    s_nop 0
    v_mul_f32 v8, v8, v9
    v_cvt_pk_bf16_f32 v8, v8, v8
    ds_write_b16 v6, v8 offset:640

    v_cvt_pk_bf16_f32 v8, v55, v55
    v_lshlrev_b32 v8, 16, v8
    v_mul_f32 v9, 0xbfb8aa3b, v8
    v_exp_f32 v9, v9
    s_nop 0
    v_add_f32 v9, 1.0, v9
    v_rcp_f32 v9, v9
    s_nop 0
    v_mul_f32 v8, v8, v9
    v_cvt_pk_bf16_f32 v8, v8, v8
    ds_write_b16 v6, v8 offset:880

    v_cvt_pk_bf16_f32 v8, v56, v56
    v_lshlrev_b32 v8, 16, v8
    v_mul_f32 v9, 0xbfb8aa3b, v8
    v_exp_f32 v9, v9
    s_nop 0
    v_add_f32 v9, 1.0, v9
    v_rcp_f32 v9, v9
    s_nop 0
    v_mul_f32 v8, v8, v9
    v_cvt_pk_bf16_f32 v8, v8, v8
    ds_write_b16 v6, v8 offset:192

    v_cvt_pk_bf16_f32 v8, v57, v57
    v_lshlrev_b32 v8, 16, v8
    v_mul_f32 v9, 0xbfb8aa3b, v8
    v_exp_f32 v9, v9
    s_nop 0
    v_add_f32 v9, 1.0, v9
    v_rcp_f32 v9, v9
    s_nop 0
    v_mul_f32 v8, v8, v9
    v_cvt_pk_bf16_f32 v8, v8, v8
    ds_write_b16 v6, v8 offset:432

    v_cvt_pk_bf16_f32 v8, v58, v58
    v_lshlrev_b32 v8, 16, v8
    v_mul_f32 v9, 0xbfb8aa3b, v8
    v_exp_f32 v9, v9
    s_nop 0
    v_add_f32 v9, 1.0, v9
    v_rcp_f32 v9, v9
    s_nop 0
    v_mul_f32 v8, v8, v9
    v_cvt_pk_bf16_f32 v8, v8, v8
    ds_write_b16 v6, v8 offset:672

    v_cvt_pk_bf16_f32 v8, v59, v59
    v_lshlrev_b32 v8, 16, v8
    v_mul_f32 v9, 0xbfb8aa3b, v8
    v_exp_f32 v9, v9
    s_nop 0
    v_add_f32 v9, 1.0, v9
    v_rcp_f32 v9, v9
    s_nop 0
    v_mul_f32 v8, v8, v9
    v_cvt_pk_bf16_f32 v8, v8, v8
    ds_write_b16 v6, v8 offset:912

    v_cvt_pk_bf16_f32 v8, v60, v60
    v_lshlrev_b32 v8, 16, v8
    v_mul_f32 v9, 0xbfb8aa3b, v8
    v_exp_f32 v9, v9
    s_nop 0
    v_add_f32 v9, 1.0, v9
    v_rcp_f32 v9, v9
    s_nop 0
    v_mul_f32 v8, v8, v9
    v_cvt_pk_bf16_f32 v8, v8, v8
    ds_write_b16 v6, v8 offset:3840

    v_cvt_pk_bf16_f32 v8, v61, v61
    v_lshlrev_b32 v8, 16, v8
    v_mul_f32 v9, 0xbfb8aa3b, v8
    v_exp_f32 v9, v9
    s_nop 0
    v_add_f32 v9, 1.0, v9
    v_rcp_f32 v9, v9
    s_nop 0
    v_mul_f32 v8, v8, v9
    v_cvt_pk_bf16_f32 v8, v8, v8
    ds_write_b16 v6, v8 offset:4080

    v_cvt_pk_bf16_f32 v8, v62, v62
    v_lshlrev_b32 v8, 16, v8
    v_mul_f32 v9, 0xbfb8aa3b, v8
    v_exp_f32 v9, v9
    s_nop 0
    v_add_f32 v9, 1.0, v9
    v_rcp_f32 v9, v9
    s_nop 0
    v_mul_f32 v8, v8, v9
    v_cvt_pk_bf16_f32 v8, v8, v8
    ds_write_b16 v6, v8 offset:4320

    v_cvt_pk_bf16_f32 v8, v63, v63
    v_lshlrev_b32 v8, 16, v8
    v_mul_f32 v9, 0xbfb8aa3b, v8
    v_exp_f32 v9, v9
    s_nop 0
    v_add_f32 v9, 1.0, v9
    v_rcp_f32 v9, v9
    s_nop 0
    v_mul_f32 v8, v8, v9
    v_cvt_pk_bf16_f32 v8, v8, v8
    ds_write_b16 v6, v8 offset:4560

    v_cvt_pk_bf16_f32 v8, v64, v64
    v_lshlrev_b32 v8, 16, v8
    v_mul_f32 v9, 0xbfb8aa3b, v8
    v_exp_f32 v9, v9
    s_nop 0
    v_add_f32 v9, 1.0, v9
    v_rcp_f32 v9, v9
    s_nop 0
    v_mul_f32 v8, v8, v9
    v_cvt_pk_bf16_f32 v8, v8, v8
    ds_write_b16 v6, v8 offset:3872

    v_cvt_pk_bf16_f32 v8, v65, v65
    v_lshlrev_b32 v8, 16, v8
    v_mul_f32 v9, 0xbfb8aa3b, v8
    v_exp_f32 v9, v9
    s_nop 0
    v_add_f32 v9, 1.0, v9
    v_rcp_f32 v9, v9
    s_nop 0
    v_mul_f32 v8, v8, v9
    v_cvt_pk_bf16_f32 v8, v8, v8
    ds_write_b16 v6, v8 offset:4112

    v_cvt_pk_bf16_f32 v8, v66, v66
    v_lshlrev_b32 v8, 16, v8
    v_mul_f32 v9, 0xbfb8aa3b, v8
    v_exp_f32 v9, v9
    s_nop 0
    v_add_f32 v9, 1.0, v9
    v_rcp_f32 v9, v9
    s_nop 0
    v_mul_f32 v8, v8, v9
    v_cvt_pk_bf16_f32 v8, v8, v8
    ds_write_b16 v6, v8 offset:4352

    v_cvt_pk_bf16_f32 v8, v67, v67
    v_lshlrev_b32 v8, 16, v8
    v_mul_f32 v9, 0xbfb8aa3b, v8
    v_exp_f32 v9, v9
    s_nop 0
    v_add_f32 v9, 1.0, v9
    v_rcp_f32 v9, v9
    s_nop 0
    v_mul_f32 v8, v8, v9
    v_cvt_pk_bf16_f32 v8, v8, v8
    ds_write_b16 v6, v8 offset:4592

    v_cvt_pk_bf16_f32 v8, v68, v68
    v_lshlrev_b32 v8, 16, v8
    v_mul_f32 v9, 0xbfb8aa3b, v8
    v_exp_f32 v9, v9
    s_nop 0
    v_add_f32 v9, 1.0, v9
    v_rcp_f32 v9, v9
    s_nop 0
    v_mul_f32 v8, v8, v9
    v_cvt_pk_bf16_f32 v8, v8, v8
    ds_write_b16 v6, v8 offset:3904

    v_cvt_pk_bf16_f32 v8, v69, v69
    v_lshlrev_b32 v8, 16, v8
    v_mul_f32 v9, 0xbfb8aa3b, v8
    v_exp_f32 v9, v9
    s_nop 0
    v_add_f32 v9, 1.0, v9
    v_rcp_f32 v9, v9
    s_nop 0
    v_mul_f32 v8, v8, v9
    v_cvt_pk_bf16_f32 v8, v8, v8
    ds_write_b16 v6, v8 offset:4144

    v_cvt_pk_bf16_f32 v8, v70, v70
    v_lshlrev_b32 v8, 16, v8
    v_mul_f32 v9, 0xbfb8aa3b, v8
    v_exp_f32 v9, v9
    s_nop 0
    v_add_f32 v9, 1.0, v9
    v_rcp_f32 v9, v9
    s_nop 0
    v_mul_f32 v8, v8, v9
    v_cvt_pk_bf16_f32 v8, v8, v8
    ds_write_b16 v6, v8 offset:4384

    v_cvt_pk_bf16_f32 v8, v71, v71
    v_lshlrev_b32 v8, 16, v8
    v_mul_f32 v9, 0xbfb8aa3b, v8
    v_exp_f32 v9, v9
    s_nop 0
    v_add_f32 v9, 1.0, v9
    v_rcp_f32 v9, v9
    s_nop 0
    v_mul_f32 v8, v8, v9
    v_cvt_pk_bf16_f32 v8, v8, v8
    ds_write_b16 v6, v8 offset:4624

    v_cvt_pk_bf16_f32 v8, v72, v72
    v_lshlrev_b32 v8, 16, v8
    v_mul_f32 v9, 0xbfb8aa3b, v8
    v_exp_f32 v9, v9
    s_nop 0
    v_add_f32 v9, 1.0, v9
    v_rcp_f32 v9, v9
    s_nop 0
    v_mul_f32 v8, v8, v9
    v_cvt_pk_bf16_f32 v8, v8, v8
    ds_write_b16 v6, v8 offset:3936

    v_cvt_pk_bf16_f32 v8, v73, v73
    v_lshlrev_b32 v8, 16, v8
    v_mul_f32 v9, 0xbfb8aa3b, v8
    v_exp_f32 v9, v9
    s_nop 0
    v_add_f32 v9, 1.0, v9
    v_rcp_f32 v9, v9
    s_nop 0
    v_mul_f32 v8, v8, v9
    v_cvt_pk_bf16_f32 v8, v8, v8
    ds_write_b16 v6, v8 offset:4176

    v_cvt_pk_bf16_f32 v8, v74, v74
    v_lshlrev_b32 v8, 16, v8
    v_mul_f32 v9, 0xbfb8aa3b, v8
    v_exp_f32 v9, v9
    s_nop 0
    v_add_f32 v9, 1.0, v9
    v_rcp_f32 v9, v9
    s_nop 0
    v_mul_f32 v8, v8, v9
    v_cvt_pk_bf16_f32 v8, v8, v8
    ds_write_b16 v6, v8 offset:4416

    v_cvt_pk_bf16_f32 v8, v75, v75
    v_lshlrev_b32 v8, 16, v8
    v_mul_f32 v9, 0xbfb8aa3b, v8
    v_exp_f32 v9, v9
    s_nop 0
    v_add_f32 v9, 1.0, v9
    v_rcp_f32 v9, v9
    s_nop 0
    v_mul_f32 v8, v8, v9
    v_cvt_pk_bf16_f32 v8, v8, v8
    ds_write_b16 v6, v8 offset:4656

    v_cvt_pk_bf16_f32 v8, v76, v76
    v_lshlrev_b32 v8, 16, v8
    v_mul_f32 v9, 0xbfb8aa3b, v8
    v_exp_f32 v9, v9
    s_nop 0
    v_add_f32 v9, 1.0, v9
    v_rcp_f32 v9, v9
    s_nop 0
    v_mul_f32 v8, v8, v9
    v_cvt_pk_bf16_f32 v8, v8, v8
    ds_write_b16 v6, v8 offset:3968

    v_cvt_pk_bf16_f32 v8, v77, v77
    v_lshlrev_b32 v8, 16, v8
    v_mul_f32 v9, 0xbfb8aa3b, v8
    v_exp_f32 v9, v9
    s_nop 0
    v_add_f32 v9, 1.0, v9
    v_rcp_f32 v9, v9
    s_nop 0
    v_mul_f32 v8, v8, v9
    v_cvt_pk_bf16_f32 v8, v8, v8
    ds_write_b16 v6, v8 offset:4208

    v_cvt_pk_bf16_f32 v8, v78, v78
    v_lshlrev_b32 v8, 16, v8
    v_mul_f32 v9, 0xbfb8aa3b, v8
    v_exp_f32 v9, v9
    s_nop 0
    v_add_f32 v9, 1.0, v9
    v_rcp_f32 v9, v9
    s_nop 0
    v_mul_f32 v8, v8, v9
    v_cvt_pk_bf16_f32 v8, v8, v8
    ds_write_b16 v6, v8 offset:4448

    v_cvt_pk_bf16_f32 v8, v79, v79
    v_lshlrev_b32 v8, 16, v8
    v_mul_f32 v9, 0xbfb8aa3b, v8
    v_exp_f32 v9, v9
    s_nop 0
    v_add_f32 v9, 1.0, v9
    v_rcp_f32 v9, v9
    s_nop 0
    v_mul_f32 v8, v8, v9
    v_cvt_pk_bf16_f32 v8, v8, v8
    ds_write_b16 v6, v8 offset:4688

    v_cvt_pk_bf16_f32 v8, v80, v80
    v_lshlrev_b32 v8, 16, v8
    v_mul_f32 v9, 0xbfb8aa3b, v8
    v_exp_f32 v9, v9
    s_nop 0
    v_add_f32 v9, 1.0, v9
    v_rcp_f32 v9, v9
    s_nop 0
    v_mul_f32 v8, v8, v9
    v_cvt_pk_bf16_f32 v8, v8, v8
    ds_write_b16 v6, v8 offset:4000

    v_cvt_pk_bf16_f32 v8, v81, v81
    v_lshlrev_b32 v8, 16, v8
    v_mul_f32 v9, 0xbfb8aa3b, v8
    v_exp_f32 v9, v9
    s_nop 0
    v_add_f32 v9, 1.0, v9
    v_rcp_f32 v9, v9
    s_nop 0
    v_mul_f32 v8, v8, v9
    v_cvt_pk_bf16_f32 v8, v8, v8
    ds_write_b16 v6, v8 offset:4240

    v_cvt_pk_bf16_f32 v8, v82, v82
    v_lshlrev_b32 v8, 16, v8
    v_mul_f32 v9, 0xbfb8aa3b, v8
    v_exp_f32 v9, v9
    s_nop 0
    v_add_f32 v9, 1.0, v9
    v_rcp_f32 v9, v9
    s_nop 0
    v_mul_f32 v8, v8, v9
    v_cvt_pk_bf16_f32 v8, v8, v8
    ds_write_b16 v6, v8 offset:4480

    v_cvt_pk_bf16_f32 v8, v83, v83
    v_lshlrev_b32 v8, 16, v8
    v_mul_f32 v9, 0xbfb8aa3b, v8
    v_exp_f32 v9, v9
    s_nop 0
    v_add_f32 v9, 1.0, v9
    v_rcp_f32 v9, v9
    s_nop 0
    v_mul_f32 v8, v8, v9
    v_cvt_pk_bf16_f32 v8, v8, v8
    ds_write_b16 v6, v8 offset:4720

    v_cvt_pk_bf16_f32 v8, v84, v84
    v_lshlrev_b32 v8, 16, v8
    v_mul_f32 v9, 0xbfb8aa3b, v8
    v_exp_f32 v9, v9
    s_nop 0
    v_add_f32 v9, 1.0, v9
    v_rcp_f32 v9, v9
    s_nop 0
    v_mul_f32 v8, v8, v9
    v_cvt_pk_bf16_f32 v8, v8, v8
    ds_write_b16 v6, v8 offset:4032

    v_cvt_pk_bf16_f32 v8, v85, v85
    v_lshlrev_b32 v8, 16, v8
    v_mul_f32 v9, 0xbfb8aa3b, v8
    v_exp_f32 v9, v9
    s_nop 0
    v_add_f32 v9, 1.0, v9
    v_rcp_f32 v9, v9
    s_nop 0
    v_mul_f32 v8, v8, v9
    v_cvt_pk_bf16_f32 v8, v8, v8
    ds_write_b16 v6, v8 offset:4272

    v_cvt_pk_bf16_f32 v8, v86, v86
    v_lshlrev_b32 v8, 16, v8
    v_mul_f32 v9, 0xbfb8aa3b, v8
    v_exp_f32 v9, v9
    s_nop 0
    v_add_f32 v9, 1.0, v9
    v_rcp_f32 v9, v9
    s_nop 0
    v_mul_f32 v8, v8, v9
    v_cvt_pk_bf16_f32 v8, v8, v8
    ds_write_b16 v6, v8 offset:4512

    v_cvt_pk_bf16_f32 v8, v87, v87
    v_lshlrev_b32 v8, 16, v8
    v_mul_f32 v9, 0xbfb8aa3b, v8
    v_exp_f32 v9, v9
    s_nop 0
    v_add_f32 v9, 1.0, v9
    v_rcp_f32 v9, v9
    s_nop 0
    v_mul_f32 v8, v8, v9
    v_cvt_pk_bf16_f32 v8, v8, v8
    ds_write_b16 v6, v8 offset:4752

    s_waitcnt lgkmcnt(0)
    s_barrier
    s_lshl_b32 s14, s12, 7
    s_mul_i32 s14, s14, 3584
    s_mul_i32 s15, s13, 224
    s_add_u32 s15, s15, s14
    s_add_u32 s15, s15, 10485760
    s_mov_b32 s16, 0x12492493

    v_add_u32 v8, 0, v0
    v_mul_hi_u32 v9, v8, s16
    v_mul_u32_u24 v10, 14, v9
    v_sub_u32 v10, v8, v10
    v_mul_u32_u24 v11, 240, v9
    v_lshl_add_u32 v11, v10, 4, v11
    ds_read_b128 v[96:99], v11
    v_mul_u32_u24 v128, 3584, v9
    v_lshl_add_u32 v128, v10, 4, v128
    v_add_u32 v128, s15, v128

    v_add_u32 v8, 256, v0
    v_mul_hi_u32 v9, v8, s16
    v_mul_u32_u24 v10, 14, v9
    v_sub_u32 v10, v8, v10
    v_mul_u32_u24 v11, 240, v9
    v_lshl_add_u32 v11, v10, 4, v11
    ds_read_b128 v[100:103], v11
    v_mul_u32_u24 v129, 3584, v9
    v_lshl_add_u32 v129, v10, 4, v129
    v_add_u32 v129, s15, v129

    v_add_u32 v8, 512, v0
    v_mul_hi_u32 v9, v8, s16
    v_mul_u32_u24 v10, 14, v9
    v_sub_u32 v10, v8, v10
    v_mul_u32_u24 v11, 240, v9
    v_lshl_add_u32 v11, v10, 4, v11
    ds_read_b128 v[104:107], v11
    v_mul_u32_u24 v130, 3584, v9
    v_lshl_add_u32 v130, v10, 4, v130
    v_add_u32 v130, s15, v130

    v_add_u32 v8, 768, v0
    v_mul_hi_u32 v9, v8, s16
    v_mul_u32_u24 v10, 14, v9
    v_sub_u32 v10, v8, v10
    v_mul_u32_u24 v11, 240, v9
    v_lshl_add_u32 v11, v10, 4, v11
    ds_read_b128 v[108:111], v11
    v_mul_u32_u24 v131, 3584, v9
    v_lshl_add_u32 v131, v10, 4, v131
    v_add_u32 v131, s15, v131

    v_add_u32 v8, 1024, v0
    v_mul_hi_u32 v9, v8, s16
    v_mul_u32_u24 v10, 14, v9
    v_sub_u32 v10, v8, v10
    v_mul_u32_u24 v11, 240, v9
    v_lshl_add_u32 v11, v10, 4, v11
    ds_read_b128 v[112:115], v11
    v_mul_u32_u24 v132, 3584, v9
    v_lshl_add_u32 v132, v10, 4, v132
    v_add_u32 v132, s15, v132

    v_add_u32 v8, 1280, v0
    v_mul_hi_u32 v9, v8, s16
    v_mul_u32_u24 v10, 14, v9
    v_sub_u32 v10, v8, v10
    v_mul_u32_u24 v11, 240, v9
    v_lshl_add_u32 v11, v10, 4, v11
    ds_read_b128 v[116:119], v11
    v_mul_u32_u24 v133, 3584, v9
    v_lshl_add_u32 v133, v10, 4, v133
    v_add_u32 v133, s15, v133

    v_add_u32 v8, 1536, v0
    v_mul_hi_u32 v9, v8, s16
    v_mul_u32_u24 v10, 14, v9
    v_sub_u32 v10, v8, v10
    v_mul_u32_u24 v11, 240, v9
    v_lshl_add_u32 v11, v10, 4, v11
    ds_read_b128 v[120:123], v11
    v_mul_u32_u24 v134, 3584, v9
    v_lshl_add_u32 v134, v10, 4, v134
    v_add_u32 v134, s15, v134

    s_waitcnt lgkmcnt(0)
    buffer_store_dwordx4 v[96:99], v128, s[8:11], 0 offen
    buffer_store_dwordx4 v[100:103], v129, s[8:11], 0 offen
    buffer_store_dwordx4 v[104:107], v130, s[8:11], 0 offen
    buffer_store_dwordx4 v[108:111], v131, s[8:11], 0 offen
    buffer_store_dwordx4 v[112:115], v132, s[8:11], 0 offen
    buffer_store_dwordx4 v[116:119], v133, s[8:11], 0 offen
    buffer_store_dwordx4 v[120:123], v134, s[8:11], 0 offen
LD_done:
    s_endpgm
.section .rodata,"a"
.p2align 6
.amdhsa_kernel ffn1_kernel
  .amdhsa_next_free_vgpr 256
  .amdhsa_next_free_sgpr 102
  .amdhsa_accum_offset 256
  .amdhsa_group_segment_fixed_size 0
  .amdhsa_kernarg_size 120
  .amdhsa_user_sgpr_count 2
  .amdhsa_user_sgpr_kernarg_segment_ptr 1
  .amdhsa_system_sgpr_workgroup_id_x 1
.end_amdhsa_kernel
.text
.p2align 8
ffn2_kernel:
    s_cmp_ge_u32 s2, 256
    s_cbranch_scc1 LE_done
    s_load_dwordx2 s[4:5], s[0:1], 112
    s_load_dwordx2 s[6:7], s[0:1], 96
    s_waitcnt lgkmcnt(0)

    s_mov_b32 s8, s4
    s_mov_b32 s9, s5
    s_mov_b32 s10, 33554432
    s_mov_b32 s11, 0x00020000
    s_mov_b32 s16, s6
    s_mov_b32 s17, s7
    s_mov_b32 s18, 2097152
    s_mov_b32 s19, 0x00020000
    s_and_b32 s12, s2, 7
    s_lshl_b32 s12, s12, 2
    s_lshr_b32 s13, s2, 6
    s_add_u32 s12, s12, s13
    s_bfe_u32 s13, s2, 0x30003
    v_and_b32 v1, 31, v0
    v_bfe_u32 v2, v0, 5, 1
    v_bfe_u32 v3, v0, 6, 1
    v_bfe_u32 v4, v0, 7, 1
    v_lshrrev_b32 v14, 8, v0
    v_mul_u32_u24 v15, 1792, v14
    s_lshl_b32 s14, s12, 6
    v_lshl_add_u32 v5, v4, 5, s14
    v_add_u32 v5, v5, v1
    v_mul_u32_u24 v5, 3584, v5
    v_lshl_add_u32 v5, v2, 4, v5
    v_add_u32 v5, 10485760, v5
    v_add_u32 v5, v5, v15
    s_lshl_b32 s15, s13, 6
    v_lshl_add_u32 v6, v3, 5, s15
    v_add_u32 v6, v6, v1
    v_mul_u32_u24 v6, 3584, v6
    v_lshl_add_u32 v6, v2, 4, v6
    v_add_u32 v6, 6291456, v6
    v_add_u32 v6, v6, v15

    v_and_b32 v16, 15, v0
    v_bfe_u32 v17, v0, 4, 4
    s_mul_i32 s20, s14, 3584
    s_add_u32 s20, s20, 10485760
    v_mul_u32_u24 v18, 3584, v17
    v_lshl_add_u32 v18, v16, 4, v18
    v_add_u32 v19, s20, v18
    s_mul_i32 s21, s15, 3584
    s_add_u32 s21, s21, 6291456
    v_add_u32 v20, s21, v18
    v_mul_u32_u24 v21, 272, v17
    v_lshl_add_u32 v21, v16, 4, v21
    v_lshl_add_u32 v22, v4, 5, v1
    v_mul_u32_u24 v22, 272, v22
    v_lshl_add_u32 v22, v2, 4, v22
    v_lshl_add_u32 v23, v3, 5, v1
    v_mul_u32_u24 v23, 272, v23
    v_lshl_add_u32 v23, v2, 4, v23
    v_add_u32 v23, 17408, v23
    v_lshrrev_b32 v26, 8, v0
    v_mul_u32_u24 v27, 1792, v26
    v_add_u32 v19, v19, v27
    v_add_u32 v20, v20, v27
    v_mul_u32_u24 v27, 69632, v26
    v_add_u32 v21, v21, v27
    v_add_u32 v22, v22, v27
    v_add_u32 v23, v23, v27

    v_mov_b32 v32, 0
    v_mov_b32 v33, 0
    v_mov_b32 v34, 0
    v_mov_b32 v35, 0
    v_mov_b32 v36, 0
    v_mov_b32 v37, 0
    v_mov_b32 v38, 0
    v_mov_b32 v39, 0
    v_mov_b32 v40, 0
    v_mov_b32 v41, 0
    v_mov_b32 v42, 0
    v_mov_b32 v43, 0
    v_mov_b32 v44, 0
    v_mov_b32 v45, 0
    v_mov_b32 v46, 0
    v_mov_b32 v47, 0
    v_add_u32 v24, 0, v19
    buffer_load_dwordx4 v[64:67], v24, s[8:11], 0 offen offset:0
    v_add_u32 v24, 0, v20
    buffer_load_dwordx4 v[80:83], v24, s[8:11], 0 offen offset:0
    v_add_u32 v24, 57344, v19
    buffer_load_dwordx4 v[68:71], v24, s[8:11], 0 offen offset:0
    v_add_u32 v24, 57344, v20
    buffer_load_dwordx4 v[84:87], v24, s[8:11], 0 offen offset:0
    v_add_u32 v24, 114688, v19
    buffer_load_dwordx4 v[72:75], v24, s[8:11], 0 offen offset:0
    v_add_u32 v24, 114688, v20
    buffer_load_dwordx4 v[88:91], v24, s[8:11], 0 offen offset:0
    v_add_u32 v24, 172032, v19
    buffer_load_dwordx4 v[76:79], v24, s[8:11], 0 offen offset:0
    v_add_u32 v24, 172032, v20
    buffer_load_dwordx4 v[92:95], v24, s[8:11], 0 offen offset:0
    v_add_u32 v24, 0, v19
    buffer_load_dwordx4 v[96:99], v24, s[8:11], 0 offen offset:256
    v_add_u32 v24, 0, v20
    buffer_load_dwordx4 v[112:115], v24, s[8:11], 0 offen offset:256
    v_add_u32 v24, 57344, v19
    buffer_load_dwordx4 v[100:103], v24, s[8:11], 0 offen offset:256
    v_add_u32 v24, 57344, v20
    buffer_load_dwordx4 v[116:119], v24, s[8:11], 0 offen offset:256
    v_add_u32 v24, 114688, v19
    buffer_load_dwordx4 v[104:107], v24, s[8:11], 0 offen offset:256
    v_add_u32 v24, 114688, v20
    buffer_load_dwordx4 v[120:123], v24, s[8:11], 0 offen offset:256
    v_add_u32 v24, 172032, v19
    buffer_load_dwordx4 v[108:111], v24, s[8:11], 0 offen offset:256
    v_add_u32 v24, 172032, v20
    buffer_load_dwordx4 v[124:127], v24, s[8:11], 0 offen offset:256
    v_add_u32 v24, 0, v19
    buffer_load_dwordx4 v[128:131], v24, s[8:11], 0 offen offset:512
    v_add_u32 v24, 0, v20
    buffer_load_dwordx4 v[144:147], v24, s[8:11], 0 offen offset:512
    v_add_u32 v24, 57344, v19
    buffer_load_dwordx4 v[132:135], v24, s[8:11], 0 offen offset:512
    v_add_u32 v24, 57344, v20
    buffer_load_dwordx4 v[148:151], v24, s[8:11], 0 offen offset:512
    v_add_u32 v24, 114688, v19
    buffer_load_dwordx4 v[136:139], v24, s[8:11], 0 offen offset:512
    v_add_u32 v24, 114688, v20
    buffer_load_dwordx4 v[152:155], v24, s[8:11], 0 offen offset:512
    v_add_u32 v24, 172032, v19
    buffer_load_dwordx4 v[140:143], v24, s[8:11], 0 offen offset:512
    v_add_u32 v24, 172032, v20
    buffer_load_dwordx4 v[156:159], v24, s[8:11], 0 offen offset:512
    s_waitcnt vmcnt(16)
    ds_write_b128 v21, v[64:67] offset:0
    ds_write_b128 v21, v[80:83] offset:17408
    ds_write_b128 v21, v[68:71] offset:4352
    ds_write_b128 v21, v[84:87] offset:21760
    ds_write_b128 v21, v[72:75] offset:8704
    ds_write_b128 v21, v[88:91] offset:26112
    ds_write_b128 v21, v[76:79] offset:13056
    ds_write_b128 v21, v[92:95] offset:30464
    s_waitcnt lgkmcnt(0)
    s_barrier
    v_add_u32 v24, 0, v19
    buffer_load_dwordx4 v[64:67], v24, s[8:11], 0 offen offset:768
    v_add_u32 v24, 0, v20
    buffer_load_dwordx4 v[80:83], v24, s[8:11], 0 offen offset:768
    v_add_u32 v24, 57344, v19
    buffer_load_dwordx4 v[68:71], v24, s[8:11], 0 offen offset:768
    v_add_u32 v24, 57344, v20
    buffer_load_dwordx4 v[84:87], v24, s[8:11], 0 offen offset:768
    v_add_u32 v24, 114688, v19
    buffer_load_dwordx4 v[72:75], v24, s[8:11], 0 offen offset:768
    v_add_u32 v24, 114688, v20
    buffer_load_dwordx4 v[88:91], v24, s[8:11], 0 offen offset:768
    v_add_u32 v24, 172032, v19
    buffer_load_dwordx4 v[76:79], v24, s[8:11], 0 offen offset:768
    v_add_u32 v24, 172032, v20
    buffer_load_dwordx4 v[92:95], v24, s[8:11], 0 offen offset:768
    ds_read_b128 v[160:163], v22 offset:0
    ds_read_b128 v[164:167], v23 offset:0
    ds_read_b128 v[168:171], v22 offset:32
    ds_read_b128 v[172:175], v23 offset:32
    ds_read_b128 v[176:179], v22 offset:64
    ds_read_b128 v[180:183], v23 offset:64
    ds_read_b128 v[184:187], v22 offset:96
    ds_read_b128 v[188:191], v23 offset:96
    ds_read_b128 v[192:195], v22 offset:128
    ds_read_b128 v[196:199], v23 offset:128
    ds_read_b128 v[200:203], v22 offset:160
    ds_read_b128 v[204:207], v23 offset:160
    ds_read_b128 v[208:211], v22 offset:192
    ds_read_b128 v[212:215], v23 offset:192
    ds_read_b128 v[216:219], v22 offset:224
    ds_read_b128 v[220:223], v23 offset:224
    s_waitcnt lgkmcnt(14)
    v_mfma_f32_32x32x16_bf16 v[32:47], v[160:163], v[164:167], v[32:47]
    s_waitcnt lgkmcnt(12)
    v_mfma_f32_32x32x16_bf16 v[32:47], v[168:171], v[172:175], v[32:47]
    s_waitcnt lgkmcnt(10)
    v_mfma_f32_32x32x16_bf16 v[32:47], v[176:179], v[180:183], v[32:47]
    s_waitcnt lgkmcnt(8)
    v_mfma_f32_32x32x16_bf16 v[32:47], v[184:187], v[188:191], v[32:47]
    s_waitcnt lgkmcnt(6)
    v_mfma_f32_32x32x16_bf16 v[32:47], v[192:195], v[196:199], v[32:47]
    s_waitcnt lgkmcnt(4)
    v_mfma_f32_32x32x16_bf16 v[32:47], v[200:203], v[204:207], v[32:47]
    s_waitcnt lgkmcnt(2)
    v_mfma_f32_32x32x16_bf16 v[32:47], v[208:211], v[212:215], v[32:47]
    s_waitcnt lgkmcnt(0)
    v_mfma_f32_32x32x16_bf16 v[32:47], v[216:219], v[220:223], v[32:47]
    s_waitcnt vmcnt(16)
    ds_write_b128 v21, v[96:99] offset:34816
    ds_write_b128 v21, v[112:115] offset:52224
    ds_write_b128 v21, v[100:103] offset:39168
    ds_write_b128 v21, v[116:119] offset:56576
    ds_write_b128 v21, v[104:107] offset:43520
    ds_write_b128 v21, v[120:123] offset:60928
    ds_write_b128 v21, v[108:111] offset:47872
    ds_write_b128 v21, v[124:127] offset:65280
    s_waitcnt lgkmcnt(0)
    s_barrier
    v_add_u32 v24, 0, v19
    buffer_load_dwordx4 v[96:99], v24, s[8:11], 0 offen offset:1024
    v_add_u32 v24, 0, v20
    buffer_load_dwordx4 v[112:115], v24, s[8:11], 0 offen offset:1024
    v_add_u32 v24, 57344, v19
    buffer_load_dwordx4 v[100:103], v24, s[8:11], 0 offen offset:1024
    v_add_u32 v24, 57344, v20
    buffer_load_dwordx4 v[116:119], v24, s[8:11], 0 offen offset:1024
    v_add_u32 v24, 114688, v19
    buffer_load_dwordx4 v[104:107], v24, s[8:11], 0 offen offset:1024
    v_add_u32 v24, 114688, v20
    buffer_load_dwordx4 v[120:123], v24, s[8:11], 0 offen offset:1024
    v_add_u32 v24, 172032, v19
    buffer_load_dwordx4 v[108:111], v24, s[8:11], 0 offen offset:1024
    v_add_u32 v24, 172032, v20
    buffer_load_dwordx4 v[124:127], v24, s[8:11], 0 offen offset:1024
    ds_read_b128 v[160:163], v22 offset:34816
    ds_read_b128 v[164:167], v23 offset:34816
    ds_read_b128 v[168:171], v22 offset:34848
    ds_read_b128 v[172:175], v23 offset:34848
    ds_read_b128 v[176:179], v22 offset:34880
    ds_read_b128 v[180:183], v23 offset:34880
    ds_read_b128 v[184:187], v22 offset:34912
    ds_read_b128 v[188:191], v23 offset:34912
    ds_read_b128 v[192:195], v22 offset:34944
    ds_read_b128 v[196:199], v23 offset:34944
    ds_read_b128 v[200:203], v22 offset:34976
    ds_read_b128 v[204:207], v23 offset:34976
    ds_read_b128 v[208:211], v22 offset:35008
    ds_read_b128 v[212:215], v23 offset:35008
    ds_read_b128 v[216:219], v22 offset:35040
    ds_read_b128 v[220:223], v23 offset:35040
    s_waitcnt lgkmcnt(14)
    v_mfma_f32_32x32x16_bf16 v[32:47], v[160:163], v[164:167], v[32:47]
    s_waitcnt lgkmcnt(12)
    v_mfma_f32_32x32x16_bf16 v[32:47], v[168:171], v[172:175], v[32:47]
    s_waitcnt lgkmcnt(10)
    v_mfma_f32_32x32x16_bf16 v[32:47], v[176:179], v[180:183], v[32:47]
    s_waitcnt lgkmcnt(8)
    v_mfma_f32_32x32x16_bf16 v[32:47], v[184:187], v[188:191], v[32:47]
    s_waitcnt lgkmcnt(6)
    v_mfma_f32_32x32x16_bf16 v[32:47], v[192:195], v[196:199], v[32:47]
    s_waitcnt lgkmcnt(4)
    v_mfma_f32_32x32x16_bf16 v[32:47], v[200:203], v[204:207], v[32:47]
    s_waitcnt lgkmcnt(2)
    v_mfma_f32_32x32x16_bf16 v[32:47], v[208:211], v[212:215], v[32:47]
    s_waitcnt lgkmcnt(0)
    v_mfma_f32_32x32x16_bf16 v[32:47], v[216:219], v[220:223], v[32:47]
    s_waitcnt vmcnt(16)
    ds_write_b128 v21, v[128:131] offset:0
    ds_write_b128 v21, v[144:147] offset:17408
    ds_write_b128 v21, v[132:135] offset:4352
    ds_write_b128 v21, v[148:151] offset:21760
    ds_write_b128 v21, v[136:139] offset:8704
    ds_write_b128 v21, v[152:155] offset:26112
    ds_write_b128 v21, v[140:143] offset:13056
    ds_write_b128 v21, v[156:159] offset:30464
    s_waitcnt lgkmcnt(0)
    s_barrier
    v_add_u32 v24, 0, v19
    buffer_load_dwordx4 v[128:131], v24, s[8:11], 0 offen offset:1280
    v_add_u32 v24, 0, v20
    buffer_load_dwordx4 v[144:147], v24, s[8:11], 0 offen offset:1280
    v_add_u32 v24, 57344, v19
    buffer_load_dwordx4 v[132:135], v24, s[8:11], 0 offen offset:1280
    v_add_u32 v24, 57344, v20
    buffer_load_dwordx4 v[148:151], v24, s[8:11], 0 offen offset:1280
    v_add_u32 v24, 114688, v19
    buffer_load_dwordx4 v[136:139], v24, s[8:11], 0 offen offset:1280
    v_add_u32 v24, 114688, v20
    buffer_load_dwordx4 v[152:155], v24, s[8:11], 0 offen offset:1280
    v_add_u32 v24, 172032, v19
    buffer_load_dwordx4 v[140:143], v24, s[8:11], 0 offen offset:1280
    v_add_u32 v24, 172032, v20
    buffer_load_dwordx4 v[156:159], v24, s[8:11], 0 offen offset:1280
    ds_read_b128 v[160:163], v22 offset:0
    ds_read_b128 v[164:167], v23 offset:0
    ds_read_b128 v[168:171], v22 offset:32
    ds_read_b128 v[172:175], v23 offset:32
    ds_read_b128 v[176:179], v22 offset:64
    ds_read_b128 v[180:183], v23 offset:64
    ds_read_b128 v[184:187], v22 offset:96
    ds_read_b128 v[188:191], v23 offset:96
    ds_read_b128 v[192:195], v22 offset:128
    ds_read_b128 v[196:199], v23 offset:128
    ds_read_b128 v[200:203], v22 offset:160
    ds_read_b128 v[204:207], v23 offset:160
    ds_read_b128 v[208:211], v22 offset:192
    ds_read_b128 v[212:215], v23 offset:192
    ds_read_b128 v[216:219], v22 offset:224
    ds_read_b128 v[220:223], v23 offset:224
    s_waitcnt lgkmcnt(14)
    v_mfma_f32_32x32x16_bf16 v[32:47], v[160:163], v[164:167], v[32:47]
    s_waitcnt lgkmcnt(12)
    v_mfma_f32_32x32x16_bf16 v[32:47], v[168:171], v[172:175], v[32:47]
    s_waitcnt lgkmcnt(10)
    v_mfma_f32_32x32x16_bf16 v[32:47], v[176:179], v[180:183], v[32:47]
    s_waitcnt lgkmcnt(8)
    v_mfma_f32_32x32x16_bf16 v[32:47], v[184:187], v[188:191], v[32:47]
    s_waitcnt lgkmcnt(6)
    v_mfma_f32_32x32x16_bf16 v[32:47], v[192:195], v[196:199], v[32:47]
    s_waitcnt lgkmcnt(4)
    v_mfma_f32_32x32x16_bf16 v[32:47], v[200:203], v[204:207], v[32:47]
    s_waitcnt lgkmcnt(2)
    v_mfma_f32_32x32x16_bf16 v[32:47], v[208:211], v[212:215], v[32:47]
    s_waitcnt lgkmcnt(0)
    v_mfma_f32_32x32x16_bf16 v[32:47], v[216:219], v[220:223], v[32:47]
    s_waitcnt vmcnt(16)
    ds_write_b128 v21, v[64:67] offset:34816
    ds_write_b128 v21, v[80:83] offset:52224
    ds_write_b128 v21, v[68:71] offset:39168
    ds_write_b128 v21, v[84:87] offset:56576
    ds_write_b128 v21, v[72:75] offset:43520
    ds_write_b128 v21, v[88:91] offset:60928
    ds_write_b128 v21, v[76:79] offset:47872
    ds_write_b128 v21, v[92:95] offset:65280
    s_waitcnt lgkmcnt(0)
    s_barrier
    v_add_u32 v24, 0, v19
    buffer_load_dwordx4 v[64:67], v24, s[8:11], 0 offen offset:1536
    v_add_u32 v24, 0, v20
    buffer_load_dwordx4 v[80:83], v24, s[8:11], 0 offen offset:1536
    v_add_u32 v24, 57344, v19
    buffer_load_dwordx4 v[68:71], v24, s[8:11], 0 offen offset:1536
    v_add_u32 v24, 57344, v20
    buffer_load_dwordx4 v[84:87], v24, s[8:11], 0 offen offset:1536
    v_add_u32 v24, 114688, v19
    buffer_load_dwordx4 v[72:75], v24, s[8:11], 0 offen offset:1536
    v_add_u32 v24, 114688, v20
    buffer_load_dwordx4 v[88:91], v24, s[8:11], 0 offen offset:1536
    v_add_u32 v24, 172032, v19
    buffer_load_dwordx4 v[76:79], v24, s[8:11], 0 offen offset:1536
    v_add_u32 v24, 172032, v20
    buffer_load_dwordx4 v[92:95], v24, s[8:11], 0 offen offset:1536
    ds_read_b128 v[160:163], v22 offset:34816
    ds_read_b128 v[164:167], v23 offset:34816
    ds_read_b128 v[168:171], v22 offset:34848
    ds_read_b128 v[172:175], v23 offset:34848
    ds_read_b128 v[176:179], v22 offset:34880
    ds_read_b128 v[180:183], v23 offset:34880
    ds_read_b128 v[184:187], v22 offset:34912
    ds_read_b128 v[188:191], v23 offset:34912
    ds_read_b128 v[192:195], v22 offset:34944
    ds_read_b128 v[196:199], v23 offset:34944
    ds_read_b128 v[200:203], v22 offset:34976
    ds_read_b128 v[204:207], v23 offset:34976
    ds_read_b128 v[208:211], v22 offset:35008
    ds_read_b128 v[212:215], v23 offset:35008
    ds_read_b128 v[216:219], v22 offset:35040
    ds_read_b128 v[220:223], v23 offset:35040
    s_waitcnt lgkmcnt(14)
    v_mfma_f32_32x32x16_bf16 v[32:47], v[160:163], v[164:167], v[32:47]
    s_waitcnt lgkmcnt(12)
    v_mfma_f32_32x32x16_bf16 v[32:47], v[168:171], v[172:175], v[32:47]
    s_waitcnt lgkmcnt(10)
    v_mfma_f32_32x32x16_bf16 v[32:47], v[176:179], v[180:183], v[32:47]
    s_waitcnt lgkmcnt(8)
    v_mfma_f32_32x32x16_bf16 v[32:47], v[184:187], v[188:191], v[32:47]
    s_waitcnt lgkmcnt(6)
    v_mfma_f32_32x32x16_bf16 v[32:47], v[192:195], v[196:199], v[32:47]
    s_waitcnt lgkmcnt(4)
    v_mfma_f32_32x32x16_bf16 v[32:47], v[200:203], v[204:207], v[32:47]
    s_waitcnt lgkmcnt(2)
    v_mfma_f32_32x32x16_bf16 v[32:47], v[208:211], v[212:215], v[32:47]
    s_waitcnt lgkmcnt(0)
    v_mfma_f32_32x32x16_bf16 v[32:47], v[216:219], v[220:223], v[32:47]
    s_waitcnt vmcnt(16)
    ds_write_b128 v21, v[96:99] offset:0
    ds_write_b128 v21, v[112:115] offset:17408
    ds_write_b128 v21, v[100:103] offset:4352
    ds_write_b128 v21, v[116:119] offset:21760
    ds_write_b128 v21, v[104:107] offset:8704
    ds_write_b128 v21, v[120:123] offset:26112
    ds_write_b128 v21, v[108:111] offset:13056
    ds_write_b128 v21, v[124:127] offset:30464
    s_waitcnt lgkmcnt(0)
    s_barrier
    ds_read_b128 v[160:163], v22 offset:0
    ds_read_b128 v[164:167], v23 offset:0
    ds_read_b128 v[168:171], v22 offset:32
    ds_read_b128 v[172:175], v23 offset:32
    ds_read_b128 v[176:179], v22 offset:64
    ds_read_b128 v[180:183], v23 offset:64
    ds_read_b128 v[184:187], v22 offset:96
    ds_read_b128 v[188:191], v23 offset:96
    ds_read_b128 v[192:195], v22 offset:128
    ds_read_b128 v[196:199], v23 offset:128
    ds_read_b128 v[200:203], v22 offset:160
    ds_read_b128 v[204:207], v23 offset:160
    ds_read_b128 v[208:211], v22 offset:192
    ds_read_b128 v[212:215], v23 offset:192
    ds_read_b128 v[216:219], v22 offset:224
    ds_read_b128 v[220:223], v23 offset:224
    s_waitcnt lgkmcnt(14)
    v_mfma_f32_32x32x16_bf16 v[32:47], v[160:163], v[164:167], v[32:47]
    s_waitcnt lgkmcnt(12)
    v_mfma_f32_32x32x16_bf16 v[32:47], v[168:171], v[172:175], v[32:47]
    s_waitcnt lgkmcnt(10)
    v_mfma_f32_32x32x16_bf16 v[32:47], v[176:179], v[180:183], v[32:47]
    s_waitcnt lgkmcnt(8)
    v_mfma_f32_32x32x16_bf16 v[32:47], v[184:187], v[188:191], v[32:47]
    s_waitcnt lgkmcnt(6)
    v_mfma_f32_32x32x16_bf16 v[32:47], v[192:195], v[196:199], v[32:47]
    s_waitcnt lgkmcnt(4)
    v_mfma_f32_32x32x16_bf16 v[32:47], v[200:203], v[204:207], v[32:47]
    s_waitcnt lgkmcnt(2)
    v_mfma_f32_32x32x16_bf16 v[32:47], v[208:211], v[212:215], v[32:47]
    s_waitcnt lgkmcnt(0)
    v_mfma_f32_32x32x16_bf16 v[32:47], v[216:219], v[220:223], v[32:47]
    s_waitcnt vmcnt(8)
    ds_write_b128 v21, v[128:131] offset:34816
    ds_write_b128 v21, v[144:147] offset:52224
    ds_write_b128 v21, v[132:135] offset:39168
    ds_write_b128 v21, v[148:151] offset:56576
    ds_write_b128 v21, v[136:139] offset:43520
    ds_write_b128 v21, v[152:155] offset:60928
    ds_write_b128 v21, v[140:143] offset:47872
    ds_write_b128 v21, v[156:159] offset:65280
    s_waitcnt lgkmcnt(0)
    s_barrier
    ds_read_b128 v[160:163], v22 offset:34816
    ds_read_b128 v[164:167], v23 offset:34816
    ds_read_b128 v[168:171], v22 offset:34848
    ds_read_b128 v[172:175], v23 offset:34848
    ds_read_b128 v[176:179], v22 offset:34880
    ds_read_b128 v[180:183], v23 offset:34880
    ds_read_b128 v[184:187], v22 offset:34912
    ds_read_b128 v[188:191], v23 offset:34912
    ds_read_b128 v[192:195], v22 offset:34944
    ds_read_b128 v[196:199], v23 offset:34944
    ds_read_b128 v[200:203], v22 offset:34976
    ds_read_b128 v[204:207], v23 offset:34976
    ds_read_b128 v[208:211], v22 offset:35008
    ds_read_b128 v[212:215], v23 offset:35008
    ds_read_b128 v[216:219], v22 offset:35040
    ds_read_b128 v[220:223], v23 offset:35040
    s_waitcnt lgkmcnt(14)
    v_mfma_f32_32x32x16_bf16 v[32:47], v[160:163], v[164:167], v[32:47]
    s_waitcnt lgkmcnt(12)
    v_mfma_f32_32x32x16_bf16 v[32:47], v[168:171], v[172:175], v[32:47]
    s_waitcnt lgkmcnt(10)
    v_mfma_f32_32x32x16_bf16 v[32:47], v[176:179], v[180:183], v[32:47]
    s_waitcnt lgkmcnt(8)
    v_mfma_f32_32x32x16_bf16 v[32:47], v[184:187], v[188:191], v[32:47]
    s_waitcnt lgkmcnt(6)
    v_mfma_f32_32x32x16_bf16 v[32:47], v[192:195], v[196:199], v[32:47]
    s_waitcnt lgkmcnt(4)
    v_mfma_f32_32x32x16_bf16 v[32:47], v[200:203], v[204:207], v[32:47]
    s_waitcnt lgkmcnt(2)
    v_mfma_f32_32x32x16_bf16 v[32:47], v[208:211], v[212:215], v[32:47]
    s_waitcnt lgkmcnt(0)
    v_mfma_f32_32x32x16_bf16 v[32:47], v[216:219], v[220:223], v[32:47]
    s_waitcnt vmcnt(0)
    ds_write_b128 v21, v[64:67] offset:0
    ds_write_b128 v21, v[80:83] offset:17408
    ds_write_b128 v21, v[68:71] offset:4352
    ds_write_b128 v21, v[84:87] offset:21760
    ds_write_b128 v21, v[72:75] offset:8704
    ds_write_b128 v21, v[88:91] offset:26112
    ds_write_b128 v21, v[76:79] offset:13056
    ds_write_b128 v21, v[92:95] offset:30464
    s_waitcnt lgkmcnt(0)
    s_barrier
    ds_read_b128 v[160:163], v22 offset:0
    ds_read_b128 v[164:167], v23 offset:0
    ds_read_b128 v[168:171], v22 offset:32
    ds_read_b128 v[172:175], v23 offset:32
    ds_read_b128 v[176:179], v22 offset:64
    ds_read_b128 v[180:183], v23 offset:64
    ds_read_b128 v[184:187], v22 offset:96
    ds_read_b128 v[188:191], v23 offset:96
    ds_read_b128 v[192:195], v22 offset:128
    ds_read_b128 v[196:199], v23 offset:128
    ds_read_b128 v[200:203], v22 offset:160
    ds_read_b128 v[204:207], v23 offset:160
    ds_read_b128 v[208:211], v22 offset:192
    ds_read_b128 v[212:215], v23 offset:192
    ds_read_b128 v[216:219], v22 offset:224
    ds_read_b128 v[220:223], v23 offset:224
    s_waitcnt lgkmcnt(14)
    v_mfma_f32_32x32x16_bf16 v[32:47], v[160:163], v[164:167], v[32:47]
    s_waitcnt lgkmcnt(12)
    v_mfma_f32_32x32x16_bf16 v[32:47], v[168:171], v[172:175], v[32:47]
    s_waitcnt lgkmcnt(10)
    v_mfma_f32_32x32x16_bf16 v[32:47], v[176:179], v[180:183], v[32:47]
    s_waitcnt lgkmcnt(8)
    v_mfma_f32_32x32x16_bf16 v[32:47], v[184:187], v[188:191], v[32:47]
    s_waitcnt lgkmcnt(6)
    v_mfma_f32_32x32x16_bf16 v[32:47], v[192:195], v[196:199], v[32:47]
    s_waitcnt lgkmcnt(4)
    v_mfma_f32_32x32x16_bf16 v[32:47], v[200:203], v[204:207], v[32:47]
    s_waitcnt lgkmcnt(2)
    v_mfma_f32_32x32x16_bf16 v[32:47], v[208:211], v[212:215], v[32:47]
    s_waitcnt lgkmcnt(0)
    v_mfma_f32_32x32x16_bf16 v[32:47], v[216:219], v[220:223], v[32:47]
    s_nop 15
    s_nop 3
    s_barrier
    v_and_b32 v16, 255, v0
    v_lshlrev_b32 v16, 6, v16
    v_cmp_lt_u32 vcc, 255, v0
    s_and_saveexec_b64 s[22:23], vcc
    ds_write_b128 v16, v[32:35]
    ds_write_b128 v16, v[36:39] offset:16
    ds_write_b128 v16, v[40:43] offset:32
    ds_write_b128 v16, v[44:47] offset:48
    s_mov_b64 exec, s[22:23]
    s_waitcnt lgkmcnt(0)
    s_barrier
    v_cmp_lt_u32 vcc, 255, v0
    s_cbranch_vccnz LE_done
    ds_read_b128 v[48:51], v16
    ds_read_b128 v[52:55], v16 offset:16
    ds_read_b128 v[56:59], v16 offset:32
    ds_read_b128 v[60:63], v16 offset:48
    v_lshl_add_u32 v7, v3, 5, s15
    v_add_u32 v7, v7, v1
    v_lshl_add_u32 v8, v4, 5, s14
    v_lshl_add_u32 v8, v2, 2, v8
    v_lshlrev_b32 v9, 12, v7
    v_lshl_add_u32 v9, v8, 1, v9
    v_add_u32 v9, 8388608, v9
    v_lshlrev_b32 v10, 10, v8
    v_lshl_add_u32 v10, v7, 1, v10

    buffer_load_dwordx2 v[64:65], v9, s[8:11], 0 offen offset:0
    buffer_load_dwordx2 v[66:67], v9, s[8:11], 0 offen offset:16
    buffer_load_dwordx2 v[68:69], v9, s[8:11], 0 offen offset:32
    buffer_load_dwordx2 v[70:71], v9, s[8:11], 0 offen offset:48
    s_waitcnt vmcnt(0) lgkmcnt(0)
    v_add_f32 v32, v32, v48
    v_cvt_pk_bf16_f32 v12, v32, v32
    v_lshlrev_b32 v12, 16, v12
    v_lshlrev_b32 v11, 16, v64
    v_add_f32 v11, v11, v12
    v_cvt_pk_bf16_f32 v11, v11, v11
    v_add_u32 v13, 0, v10
    buffer_store_short v11, v13, s[16:19], 0 offen

    v_add_f32 v33, v33, v49
    v_cvt_pk_bf16_f32 v12, v33, v33
    v_lshlrev_b32 v12, 16, v12
    v_and_b32 v11, 0xffff0000, v64
    v_add_f32 v11, v11, v12
    v_cvt_pk_bf16_f32 v11, v11, v11
    v_add_u32 v13, 1024, v10
    buffer_store_short v11, v13, s[16:19], 0 offen

    v_add_f32 v34, v34, v50
    v_cvt_pk_bf16_f32 v12, v34, v34
    v_lshlrev_b32 v12, 16, v12
    v_lshlrev_b32 v11, 16, v65
    v_add_f32 v11, v11, v12
    v_cvt_pk_bf16_f32 v11, v11, v11
    v_add_u32 v13, 2048, v10
    buffer_store_short v11, v13, s[16:19], 0 offen

    v_add_f32 v35, v35, v51
    v_cvt_pk_bf16_f32 v12, v35, v35
    v_lshlrev_b32 v12, 16, v12
    v_and_b32 v11, 0xffff0000, v65
    v_add_f32 v11, v11, v12
    v_cvt_pk_bf16_f32 v11, v11, v11
    v_add_u32 v13, 3072, v10
    buffer_store_short v11, v13, s[16:19], 0 offen

    v_add_f32 v36, v36, v52
    v_cvt_pk_bf16_f32 v12, v36, v36
    v_lshlrev_b32 v12, 16, v12
    v_lshlrev_b32 v11, 16, v66
    v_add_f32 v11, v11, v12
    v_cvt_pk_bf16_f32 v11, v11, v11
    v_add_u32 v13, 8192, v10
    buffer_store_short v11, v13, s[16:19], 0 offen

    v_add_f32 v37, v37, v53
    v_cvt_pk_bf16_f32 v12, v37, v37
    v_lshlrev_b32 v12, 16, v12
    v_and_b32 v11, 0xffff0000, v66
    v_add_f32 v11, v11, v12
    v_cvt_pk_bf16_f32 v11, v11, v11
    v_add_u32 v13, 9216, v10
    buffer_store_short v11, v13, s[16:19], 0 offen

    v_add_f32 v38, v38, v54
    v_cvt_pk_bf16_f32 v12, v38, v38
    v_lshlrev_b32 v12, 16, v12
    v_lshlrev_b32 v11, 16, v67
    v_add_f32 v11, v11, v12
    v_cvt_pk_bf16_f32 v11, v11, v11
    v_add_u32 v13, 10240, v10
    buffer_store_short v11, v13, s[16:19], 0 offen

    v_add_f32 v39, v39, v55
    v_cvt_pk_bf16_f32 v12, v39, v39
    v_lshlrev_b32 v12, 16, v12
    v_and_b32 v11, 0xffff0000, v67
    v_add_f32 v11, v11, v12
    v_cvt_pk_bf16_f32 v11, v11, v11
    v_add_u32 v13, 11264, v10
    buffer_store_short v11, v13, s[16:19], 0 offen

    v_add_f32 v40, v40, v56
    v_cvt_pk_bf16_f32 v12, v40, v40
    v_lshlrev_b32 v12, 16, v12
    v_lshlrev_b32 v11, 16, v68
    v_add_f32 v11, v11, v12
    v_cvt_pk_bf16_f32 v11, v11, v11
    v_add_u32 v13, 16384, v10
    buffer_store_short v11, v13, s[16:19], 0 offen

    v_add_f32 v41, v41, v57
    v_cvt_pk_bf16_f32 v12, v41, v41
    v_lshlrev_b32 v12, 16, v12
    v_and_b32 v11, 0xffff0000, v68
    v_add_f32 v11, v11, v12
    v_cvt_pk_bf16_f32 v11, v11, v11
    v_add_u32 v13, 17408, v10
    buffer_store_short v11, v13, s[16:19], 0 offen

    v_add_f32 v42, v42, v58
    v_cvt_pk_bf16_f32 v12, v42, v42
    v_lshlrev_b32 v12, 16, v12
    v_lshlrev_b32 v11, 16, v69
    v_add_f32 v11, v11, v12
    v_cvt_pk_bf16_f32 v11, v11, v11
    v_add_u32 v13, 18432, v10
    buffer_store_short v11, v13, s[16:19], 0 offen

    v_add_f32 v43, v43, v59
    v_cvt_pk_bf16_f32 v12, v43, v43
    v_lshlrev_b32 v12, 16, v12
    v_and_b32 v11, 0xffff0000, v69
    v_add_f32 v11, v11, v12
    v_cvt_pk_bf16_f32 v11, v11, v11
    v_add_u32 v13, 19456, v10
    buffer_store_short v11, v13, s[16:19], 0 offen

    v_add_f32 v44, v44, v60
    v_cvt_pk_bf16_f32 v12, v44, v44
    v_lshlrev_b32 v12, 16, v12
    v_lshlrev_b32 v11, 16, v70
    v_add_f32 v11, v11, v12
    v_cvt_pk_bf16_f32 v11, v11, v11
    v_add_u32 v13, 24576, v10
    buffer_store_short v11, v13, s[16:19], 0 offen

    v_add_f32 v45, v45, v61
    v_cvt_pk_bf16_f32 v12, v45, v45
    v_lshlrev_b32 v12, 16, v12
    v_and_b32 v11, 0xffff0000, v70
    v_add_f32 v11, v11, v12
    v_cvt_pk_bf16_f32 v11, v11, v11
    v_add_u32 v13, 25600, v10
    buffer_store_short v11, v13, s[16:19], 0 offen

    v_add_f32 v46, v46, v62
    v_cvt_pk_bf16_f32 v12, v46, v46
    v_lshlrev_b32 v12, 16, v12
    v_lshlrev_b32 v11, 16, v71
    v_add_f32 v11, v11, v12
    v_cvt_pk_bf16_f32 v11, v11, v11
    v_add_u32 v13, 26624, v10
    buffer_store_short v11, v13, s[16:19], 0 offen

    v_add_f32 v47, v47, v63
    v_cvt_pk_bf16_f32 v12, v47, v47
    v_lshlrev_b32 v12, 16, v12
    v_and_b32 v11, 0xffff0000, v71
    v_add_f32 v11, v11, v12
    v_cvt_pk_bf16_f32 v11, v11, v11
    v_add_u32 v13, 27648, v10
    buffer_store_short v11, v13, s[16:19], 0 offen

LE_done:
    s_endpgm
.section .rodata,"a"
.p2align 6
.amdhsa_kernel ffn2_kernel
  .amdhsa_next_free_vgpr 256
  .amdhsa_next_free_sgpr 102
  .amdhsa_accum_offset 256
  .amdhsa_group_segment_fixed_size 0
  .amdhsa_kernarg_size 120
  .amdhsa_user_sgpr_count 2
  .amdhsa_user_sgpr_kernarg_segment_ptr 1
  .amdhsa_system_sgpr_workgroup_id_x 1
.end_amdhsa_kernel
.text
```
